```python
import torch

def _softmax(x, axis=-1):
    return torch.softmax(x, dim=axis)
def _gelu(x):
    return torch.nn.functional.gelu(x, approximate="tanh")
def _silu(x):
    return torch.nn.functional.silu(x)
def _sigmoid(x):
    return torch.sigmoid(x)
def _layernorm(x, axis=-1, eps=1e-5):
    m = x.mean(dim=axis, keepdim=True)
    v = x.var(dim=axis, keepdim=True, unbiased=False)
    return (x - m) / torch.sqrt(v + eps)
def _scatter_add(tgt, idx, src, axis=0):
    return tgt.clone().index_add_(axis, idx, src)
def _segment_sum(src, seg, n):
    out = torch.zeros((n,) + src.shape[1:], dtype=src.dtype)
    return out.index_add_(0, seg, src)
def _pad(x, pw):
    flat = tuple(v for pair in reversed(pw) for v in pair)
    return torch.nn.functional.pad(x, flat)

kernel_name = 'parallel_sum__ssm_conv_h3__dense_activation_relu__prompt'

def setup_inputs():

    _w = (lambda a: (lambda t: t.to(torch.bfloat16) if t.is_floating_point() else t)(torch.as_tensor(a)))
    def _A_setup():
        B, S, D = 1, 2048, 512
        ks = 4
        return {
            "q": _w((lambda *s: torch.randn(*s, dtype=torch.bfloat16) * 0.05)(B, S, D)),
            "k": _w((lambda *s: torch.randn(*s, dtype=torch.bfloat16) * 0.8)(B, S, D)),
            "v": _w((lambda *s: torch.randn(*s, dtype=torch.bfloat16) * 0.4)(B, S, D)),
            "shift_k": _w((lambda *s: torch.randn(*s, dtype=torch.bfloat16) * 0.8)(D, ks) * 0.5),
            "ssm_k": _w((lambda *s: torch.randn(*s, dtype=torch.bfloat16) * 0.8)(D, S) * (1.0 / S ** 0.5)),
            "ssm_D": _w((lambda *s: torch.randn(*s, dtype=torch.bfloat16) * 0.4)(D)),
        }
    _A_in = _A_setup()

    def _B_setup():
        B, S, D, Dff = 1, 2048, 512, 1792
        return {
            "x": _w((lambda *s: torch.randn(*s, dtype=torch.bfloat16) * 0.05)(B, S, D)),
            "w1": _w((lambda *s: torch.randn(*s, dtype=torch.bfloat16) * 0.05)(D, Dff)),
            "w2": _w((lambda *s: torch.randn(*s, dtype=torch.bfloat16) * 0.05)(Dff, D)),
        }
    _B_in = _B_setup()

    return {
        "A_q": _A_in["q"],
        "A_k": _A_in["k"],
        "A_v": _A_in["v"],
        "A_shift_k": _A_in["shift_k"],
        "A_ssm_k": _A_in["ssm_k"],
        "A_ssm_D": _A_in["ssm_D"],
        "B_x": _B_in["x"],
        "B_w1": _B_in["w1"],
        "B_w2": _B_in["w2"],
    }

def reference(A_q, A_k, A_v, A_shift_k, A_ssm_k, A_ssm_D, B_x, B_w1, B_w2):
    def _A_ref(q, k, v, shift_k, ssm_k, ssm_D):
        B, S, D = q.shape
        ks = shift_k.shape[-1]
        k_pad = _pad(k, ((0, 0), (ks - 1, 0), (0, 0)))
        k_shift = torch.zeros_like(k)
        for t in range(ks):
            k_shift = k_shift + k_pad[:, t:t + S, :] * shift_k[:, ks - 1 - t][None, None, :]
        kv = k_shift * v
        L = 2 * S
        kv_pad = _pad(kv, ((0, 0), (0, S), (0, 0)))
        kf_pad = _pad(ssm_k, ((0, 0), (0, S)))
        kv_f = (lambda x, axes=(-2,-1): torch.fft.rfft2(x.float(), dim=axes))(kv_pad[:, None, :, :], axes=(1, 2))
        kf_f = (lambda x, axes=(-2,-1): torch.fft.rfft2(x.float(), dim=axes))(kf_pad[:, None, :], axes=(1, 2))
        kf_f = (lambda x, *d: x.permute(*d))(kf_f, 1, 2, 0)
        y_f = kv_f * kf_f[None, :, :, :]
        y = (lambda x, s, axes=(-2,-1): torch.fft.irfft2(x, s=s, dim=axes).to(torch.bfloat16))(y_f, (1, L), axes=(1, 2))[:, 0, :S, :]
        y = y + kv * ssm_D[None, None, :]
        return q * y

    def _B_ref(x, w1, w2):
        h = torch.einsum("bsd,df->bsf", x, w1)
        zero = torch.zeros_like(h)
        h = torch.maximum(h, zero)
        return torch.einsum("bsf,fd->bsd", h, w2)

    x = A_q
    xn = _layernorm(x, axis=-1)
    return x + _A_ref(xn, A_k, A_v, A_shift_k, A_ssm_k, A_ssm_D) + _B_ref(xn, B_w1, B_w2)
```

```asm
; @launch grid=(256,1,1) block=(256,1,1) lds=163840
.amdgcn_target "amdgcn-amd-amdhsa--gfx950"
.text
.p2align 12
.fill (3328 - (L_slow1 - L_slow0)) / 4, 4, 0xbf810000
L_slow0:
L_slow_w2:
    s_mov_b32 s67, 0
L_spin_w2:
    buffer_load_dwordx2 v[24:25], v26, s[36:39], s40 offen offset:0 sc1
    s_add_u32 s67, s67, 1
    s_cmp_gt_u32 s67, 20000
    s_waitcnt vmcnt(0)
    s_cbranch_scc1 L_back_w2
    v_cmp_ne_u64 vcc, s[42:43], v[24:25]
    s_cbranch_vccnz L_spin_w2
    s_branch L_back_w2
L_slow_kv:
    s_mov_b32 s67, 0
L_spin_kv:
    buffer_load_dwordx2 v[24:25], v26, s[36:39], s40 offen offset:0 sc1
    s_add_u32 s67, s67, 1
    s_cmp_gt_u32 s67, 20000
    s_waitcnt vmcnt(0)
    s_cbranch_scc1 L_back_kv
    v_cmp_ne_u64 vcc, s[42:43], v[24:25]
    s_cbranch_vccnz L_spin_kv
    s_branch L_back_kv
L_slow_w2s:
    s_mov_b32 s67, 0
L_spin_w2s:
    buffer_load_dwordx2 v[24:25], v26, s[36:39], s40 offen offset:0 sc1
    s_add_u32 s67, s67, 1
    s_cmp_gt_u32 s67, 20000
    s_waitcnt vmcnt(0)
    s_cbranch_scc1 L_back_w2s
    v_cmp_ne_u64 vcc, s[42:43], v[24:25]
    s_cbranch_vccnz L_spin_w2s
    s_branch L_back_w2s
L_slow_kv2:
    s_mov_b32 s67, 0
L_spin_kv2:
    buffer_load_dwordx2 v[24:25], v26, s[36:39], s40 offen offset:0 sc1
    s_add_u32 s67, s67, 1
    s_cmp_gt_u32 s67, 20000
    s_waitcnt vmcnt(0)
    s_cbranch_scc1 L_back_kv2
    v_cmp_ne_u64 vcc, s[42:43], v[24:25]
    s_cbranch_vccnz L_spin_kv2
    s_branch L_back_kv2
L_slow_h0:
    s_mov_b32 s67, 0
L_spin_h0:
    buffer_load_dwordx2 v[24:25], v26, s[36:39], s40 offen offset:0 sc1
    s_add_u32 s67, s67, 1
    s_cmp_gt_u32 s67, 20000
    s_waitcnt vmcnt(0)
    s_cbranch_scc1 L_back_h0
    v_cmp_ne_u64 vcc, s[42:43], v[24:25]
    s_cbranch_vccnz L_spin_h0
    s_branch L_back_h0
L_slow_h1:
    s_mov_b32 s67, 0
L_spin_h1:
    buffer_load_dwordx2 v[24:25], v26, s[36:39], s40 offen offset:128 sc1
    s_add_u32 s67, s67, 1
    s_cmp_gt_u32 s67, 20000
    s_waitcnt vmcnt(0)
    s_cbranch_scc1 L_back_h1
    v_cmp_ne_u64 vcc, s[42:43], v[24:25]
    s_cbranch_vccnz L_spin_h1
    s_branch L_back_h1
L_slow_st:
    s_mov_b32 s67, 0
L_spin_st:
    buffer_load_dwordx4 v[124:127], v18, s[36:39], s74 offen sc1
    s_add_u32 s67, s67, 1
    s_cmp_gt_u32 s67, 20000
    s_waitcnt vmcnt(0)
    s_cbranch_scc1 L_back_st
    v_cmp_ne_u64 vcc, s[42:43], v[126:127]
    s_cbranch_vccnz L_spin_st
    s_branch L_back_st
L_slow_y:
    s_mov_b32 s67, 0
L_spin_y:
    buffer_load_dwordx4 v[160:163], v34, s[36:39], s92 offen sc1
    buffer_load_dwordx4 v[164:167], v35, s[36:39], s93 offen sc1
    s_add_u32 s67, s67, 1
    s_cmp_gt_u32 s67, 20000
    s_waitcnt vmcnt(0)
    s_cbranch_scc1 L_back_y
    v_xad_u32 v160, v168, -1, v160
    v_xad_u32 v161, v169, -1, v161
    v_xad_u32 v162, v170, -1, v162
    v_xad_u32 v163, v171, -1, v163
    v_xad_u32 v164, v172, -1, v164
    v_xad_u32 v165, v173, -1, v165
    v_xad_u32 v166, v174, -1, v166
    v_xad_u32 v167, v175, -1, v167
    v_max3_u32 v27, v160, v161, v162
    v_max3_u32 v28, v163, v164, v165
    v_max3_u32 v27, v27, v166, v167
    v_max_u32 v27, v27, v28
    v_cmp_eq_u32 vcc, -1, v27
    s_cbranch_vccnz L_spin_y
    s_branch L_back_y
L_slow1:
.globl parallel_sum__ssm_conv_h3__dense_activation_relu__prompt_kernel
.p2align 8
.type parallel_sum__ssm_conv_h3__dense_activation_relu__prompt_kernel,@function
parallel_sum__ssm_conv_h3__dense_activation_relu__prompt_kernel:
    s_cmp_ge_u32 s2, 0x100
    s_cbranch_scc1 L_end
    s_load_dwordx2 s[4:5], s[0:1], 0
    s_load_dwordx2 s[24:25], s[0:1], 56
    s_load_dwordx2 s[8:9], s[0:1], 8
    s_load_dwordx2 s[12:13], s[0:1], 16
    s_load_dwordx2 s[16:17], s[0:1], 24
    s_load_dwordx2 s[36:37], s[0:1], 88
    s_load_dwordx2 s[20:21], s[0:1], 32
    s_load_dwordx2 s[40:41], s[0:1], 40
    s_load_dwordx2 s[28:29], s[0:1], 64
    s_load_dwordx2 s[32:33], s[0:1], 72
    v_lshrrev_b32 v27, 6, v0
    v_and_b32 v1, 63, v0
    s_lshr_b32 s46, s2, 3
    v_readfirstlane_b32 s44, v27
    s_getpc_b64 s[60:61]
L_pc:
    v_and_b32 v28, 1, v0
    v_lshl_add_u32 v28, v27, 1, v28
    v_lshl_add_u32 v28, s46, 3, v28
    v_lshlrev_b32 v28, 7, v28
    s_sub_u32 s60, s60, L_pc-L_slow0
    s_subb_u32 s61, s61, 0
    v_min_u32 v28, L_codeend-L_slow0-4, v28
    v_mov_b32 v29, s61
    v_add_co_u32 v28, vcc, s60, v28
    s_and_b32 s45, s2, 7
    s_mov_b32 s6, 0x200000
    v_addc_co_u32 v29, vcc, 0, v29, vcc
    global_load_dword a255, v[28:29], off
    s_mov_b32 s7, 0x20000
    s_mov_b64 s[10:11], s[6:7]
    s_mov_b64 s[14:15], s[6:7]
    s_mov_b64 s[22:23], s[6:7]
    s_mov_b64 s[34:35], s[6:7]
    s_mov_b32 s18, 0x1000
    s_mov_b32 s19, s7
    s_mov_b32 s26, 0x1c0000
    s_mov_b32 s27, s7
    s_mov_b64 s[30:31], s[26:27]
    s_mov_b32 s38, 16777216
    s_mov_b32 s39, s7
    v_lshrrev_b32 v27, 3, v1
    v_and_b32 v28, 7, v1
    v_lshrrev_b32 v29, 4, v1
    v_lshlrev_b32 v31, 10, v27
    v_lshl_or_b32 v3, v28, 4, v31
    v_and_b32 v37, 1, v29
    v_lshlrev_b32 v37, 6, v37
    v_xor_b32 v20, v3, v37
    s_lshl_b32 s54, s44, 12
    s_lshr_b32 s60, s46, 3
    s_lshl2_add_u32 s47, s45, s60
    s_and_b32 s48, s46, 7
    s_cmp_ge_u32 s46, 28
    s_cbranch_scc1 L_spare
    s_lshr_b32 s60, s45, 1
    s_lshl_b32 s60, s60, 5
    s_add_u32 s60, s60, s46
    s_lshl2_add_u32 s60, s60, s44
    s_and_b32 s61, s45, 1
    s_lshl1_add_u32 s60, s60, s61
    s_mul_i32 s94, s60, 1792
    v_min_u32 v32, 13, v1
    v_lshlrev_b32 v32, 7, v32
    v_and_b32 v33, 15, v1
    v_lshlrev_b32 v33, 10, v33
    s_waitcnt lgkmcnt(0)
    buffer_load_dword a254, v32, s[24:27], s94 offen
    v_lshrrev_b32 v30, 5, v1
    v_lshlrev_b32 v30, 5, v30
    v_xor_b32 v96, v3, v30
    v_xor_b32 v97, 64, v96
    v_add_u32 v97, 7168, v97
    s_lshl_b32 s60, s47, 16
    s_lshl_b32 s61, s44, 14
    s_lshl_b32 s62, s48, 7
    s_add_u32 s60, s60, s62
    s_add_u32 s70, s60, s61
    s_lshl_b32 s61, s44, 10
    s_add_u32 s60, s60, s61
    s_sub_u32 s60, s60, 4096
    v_xor_b32 v98, 6, v28
    v_lshlrev_b32 v98, 4, v98
    v_add_u32 v98, s60, v98
    s_lshl_b32 s71, s44, 11
    s_lshl_b32 s72, s44, 7
    s_lshl2_add_u32 s101, s62, s72
    v_and_b32 v99, 15, v1
    v_lshlrev_b32 v99, 3, v99
    buffer_load_dword a253, v33, s[4:7], s70 offen
    s_lshr_b32 s60, s45, 1
    s_and_b32 s61, s46, 3
    s_lshl2_add_u32 s60, s60, s61
    s_lshr_b32 s63, s46, 2
    s_lshl2_add_u32 s60, s60, s44
    s_lshr_b32 s61, s60, 1
    s_lshl_b32 s61, s61, 16
    s_and_b32 s62, s44, 1
    s_lshl_b32 s62, s62, 13
    s_add_u32 s49, s61, s62
    s_add_u32 s50, s49, 15360
    s_add_u32 s51, s50, 15360
    s_add_u32 s52, s51, 15360
    v_lshlrev_b32 v37, 4, v29
    v_xor_b32 v6, v3, v37
    v_xor_b32 v7, 64, v6
    s_and_b32 s62, s45, 1
    s_mul_i32 s62, s62, 7
    s_add_u32 s62, s62, s63
    s_mul_i32 s61, s44, 57344
    s_lshl_b32 s63, s62, 8
    s_add_u32 s53, s61, s63
    v_mul_u32_u24 v38, 2560, v27
    v_add_u32 v4, v20, v38
    v_add_u32 v5, 27648, v4
    s_lshr_b32 s66, s60, 2
    s_mul_i32 s66, s66, 14
    s_add_u32 s66, s66, s62
    s_lshl_b32 s66, s66, 8
    s_add_u32 s66, s66, 12845056
    s_cmp_eq_u32 s44, 0
    s_cselect_b32 s66, s66, 16777216
    s_mul_i32 s55, s60, 112
    s_add_u32 s55, s55, s62
    s_lshl_b32 s55, s55, 10
    s_add_u32 s55, s55, 4194304
    s_add_u32 m0, s54, 65536
    s_nop 0
    buffer_load_dwordx4 v6, s[4:7], s49 offen offset:0 lds
    buffer_load_dwordx4 v7, s[4:7], s50 offen offset:1024 lds
    s_lshr_b32 s60, s44, 1
    s_lshl1_add_u32 s60, s2, s60
    s_lshl_b32 s73, s60, 12
    s_lshl_b32 s61, s2, 2
    s_mov_b32 s62, 13172736
    s_load_dwordx2 s[42:43], s[36:37], s62
    s_load_dwordx2 s[58:59], s[20:21], s73
    s_load_dword s56, s[40:41], s61
    s_and_b32 s61, s44, 1
    buffer_load_dwordx4 v6, s[4:7], s51 offen offset:2048 lds
    s_lshl_b32 s61, s61, 2
    s_sub_u32 s73, s73, s61
    s_add_u32 s73, s73, 8
    s_lshl2_add_u32 s69, s2, s44
    s_lshl_b32 s69, s69, 11
    s_lshl_b32 s65, s2, 7
    s_add_u32 s65, s65, 12582912
    s_cmp_eq_u32 s44, 0
    s_cselect_b32 s65, s65, 16777216
    v_lshlrev_b32 v2, 4, v1
    buffer_load_dwordx4 v7, s[4:7], s52 offen offset:3072 lds
    s_add_u32 m0, s54, 0
    v_lshrrev_b32 v29, 4, v1
    v_lshrrev_b32 v30, 5, v1
    v_bfe_u32 v31, v1, 1, 3
    v_xor_b32 v31, v31, v30
    v_lshlrev_b32 v31, 4, v31
    v_and_b32 v32, 31, v1
    v_lshl_add_u32 v31, v32, 7, v31
    s_add_u32 s60, s54, 65536
    v_add_u32 v31, s60, v31
    buffer_load_dwordx4 v4, s[24:27], s53 offen lds
    v_bfe_u32 v32, v1, 2, 2
    v_and_b32 v33, 3, v1
    v_bfe_u32 v35, v1, 3, 1
    v_lshlrev_b32 v35, 6, v35
    v_lshl_add_u32 v35, v32, 7, v35
    v_and_b32 v34, 1, v29
    v_lshl_add_u32 v35, v34, 5, v35
    v_lshl_add_u32 v35, v33, 3, v35
    v_lshl_add_u32 v34, v30, 10, v35
    buffer_load_dwordx4 v5, s[24:27], s53 offen offset:1024 lds
    s_add_u32 s53, s53, 229376
    s_add_u32 m0, s71, 132096
    s_add_u32 s60, s44, 0
    s_and_b32 s60, s60, 3
    s_lshl_b32 s61, s60, 5
    s_lshl_b32 s60, s60, 12
    v_xor_b32 v8, s61, v31
    v_add_u32 v12, s60, v34
    v_xor_b32 v13, 64, v12
    s_add_u32 s60, s44, 1
    buffer_load_dwordx4 v96, s[8:11], s70 offen lds
    s_add_u32 m0, s54, 81792
    s_and_b32 s60, s60, 3
    s_lshl_b32 s61, s60, 5
    s_lshl_b32 s60, s60, 12
    v_xor_b32 v9, s61, v31
    v_add_u32 v14, s60, v34
    v_xor_b32 v15, 64, v14
    s_add_u32 s60, s44, 2
    s_and_b32 s60, s60, 3
    s_lshl_b32 s61, s60, 5
    buffer_load_dwordx4 v6, s[4:7], s49 offen offset:128 lds
    s_lshl_b32 s60, s60, 12
    v_xor_b32 v10, s61, v31
    v_add_u32 v16, s60, v34
    v_xor_b32 v17, 64, v16
    s_add_u32 s60, s44, 3
    s_and_b32 s60, s60, 3
    s_lshl_b32 s61, s60, 5
    s_lshl_b32 s60, s60, 12
    v_xor_b32 v11, s61, v31
    buffer_load_dwordx4 v7, s[4:7], s50 offen offset:1152 lds
    v_add_u32 v18, s60, v34
    v_xor_b32 v19, 64, v18
    v_lshrrev_b32 v31, 2, v1
    v_xor_b32 v31, v31, v29
    v_and_b32 v31, 1, v31
    v_add_u32 v31, -1, v31
    v_and_b32 v31, 0x3f803f80, v31
    v_accvgpr_write_b32 a224, v31
    v_accvgpr_write_b32 a225, v31
    buffer_load_dwordx4 v6, s[4:7], s51 offen offset:2176 lds
    v_accvgpr_write_b32 a226, v31
    v_accvgpr_write_b32 a227, v31
    v_lshrrev_b32 v27, 4, v1
    v_bfe_u32 v28, v1, 2, 2
    v_and_b32 v29, 3, v1
    v_lshrrev_b32 v30, 2, v1
    v_lshlrev_b32 v30, 9, v30
    v_lshl_add_u32 v30, v29, 3, v30
    buffer_load_dwordx4 v7, s[4:7], s52 offen offset:3200 lds
    s_add_u32 m0, s71, 132096
    v_xor_b32 v31, s44, v28
    v_lshl_add_u32 v31, v31, 5, v30
    v_add_u32 v254, 132096, v31
    v_add_u32 v32, 3, v28
    v_and_b32 v32, 3, v32
    v_xor_b32 v32, s44, v32
    v_lshl_add_u32 v32, v32, 5, v30
    v_add_u32 v255, 131584, v32
    s_mul_i32 s61, s44, 2176
    buffer_load_dwordx4 v97, s[8:11], s70 offen offset:1024 lds
    s_add_u32 m0, s54, 2048
    s_add_u32 s61, s61, 152576
    v_bfe_u32 v33, v1, 1, 3
    v_mul_u32_u24 v33, 272, v33
    v_lshl_add_u32 v33, v27, 4, v33
    v_add_u32 v33, s61, v33
    v_and_b32 v34, 1, v1
    v_lshlrev_b32 v34, 1, v34
    s_and_b32 s60, s47, 3
    v_xor_b32 v34, s60, v34
    buffer_load_dwordx4 v4, s[24:27], s53 offen lds
    v_xor_b32 v35, 1, v34
    v_lshl_add_u32 v126, v34, 6, v33
    v_lshl_add_u32 v127, v35, 6, v33
    v_and_b32 v36, 15, v1
    v_lshlrev_b32 v36, 4, v36
    v_mul_u32_u24 v37, 272, v27
    v_add3_u32 v24, v37, v36, s61
    v_lshl_add_u32 v38, v27, 13, v36
    s_lshl2_add_u32 s60, s48, s44
    buffer_load_dwordx4 v5, s[24:27], s53 offen offset:1024 lds
    s_add_u32 s53, s53, 229376
    s_add_u32 m0, s72, 131584
    s_lshl_b32 s61, s60, 16
    s_lshl_b32 s62, s47, 8
    s_add_u32 s99, s61, s62
    s_add_u32 s100, s99, 32768
    s_add_u32 s92, s99, 0
    s_add_u32 s93, s100, 0
    s_mul_i32 s64, s60, 57344
    s_add_u32 s64, s64, 14680064
    s_cmp_eq_u32 s44, 1
    s_cbranch_scc1 L_page1
    s_cmp_eq_u32 s44, 2
    s_cbranch_scc1 L_page2
    s_cmp_eq_u32 s44, 3
    s_cbranch_scc1 L_page3
L_ret:
    s_mov_b64 exec, 0xff
    buffer_load_dwordx4 v98, s[8:11], 0 offen lds
    s_mov_b64 exec, -1
    s_add_u32 m0, s71, 140288
    s_nop 0
    buffer_load_dwordx4 v96, s[12:15], s70 offen lds
    buffer_load_dwordx4 v97, s[12:15], s70 offen offset:1024 lds
    s_add_u32 m0, s54, 98048
    buffer_load_dwordx2 v[124:125], v99, s[16:19], s101 offen
    s_waitcnt vmcnt(14)
    ds_read_b128 v[128:131], v8 offset:0
    ds_read_b128 v[132:135], v9 offset:0
    ds_read_b128 v[136:139], v10 offset:0
    ds_read_b128 v[140:143], v11 offset:0
    s_waitcnt vmcnt(12)
    s_barrier
    ds_read_b64_tr_b16 v[40:41], v12 offset:0
    ds_read_b64_tr_b16 v[42:43], v12 offset:512
    ds_read_b64_tr_b16 v[44:45], v13 offset:0
    ds_read_b64_tr_b16 v[46:47], v13 offset:512
    ds_read_b64_tr_b16 v[48:49], v14 offset:0
    ds_read_b64_tr_b16 v[50:51], v14 offset:512
    ds_read_b64_tr_b16 v[52:53], v15 offset:0
    ds_read_b64_tr_b16 v[54:55], v15 offset:512
    s_waitcnt lgkmcnt(4)
    v_mfma_f32_32x32x16_bf16 v[64:79], v[40:43], v[128:131], 0
    ds_read_b64_tr_b16 v[56:57], v16 offset:0
    ds_read_b64_tr_b16 v[58:59], v16 offset:512
    buffer_load_dwordx4 v6, s[4:7], s49 offen offset:256 lds
    v_mfma_f32_16x16x32_bf16 a[232:235], a[224:227], v[40:43], 0
    v_mfma_f32_32x32x16_bf16 v[80:95], v[44:47], v[128:131], 0
    ds_read_b64_tr_b16 v[60:61], v17 offset:0
    ds_read_b64_tr_b16 v[62:63], v17 offset:512
    buffer_load_dwordx4 v7, s[4:7], s50 offen offset:1280 lds
    v_mfma_f32_16x16x32_bf16 a[236:239], a[224:227], v[44:47], 0
    v_mfma_f32_16x16x32_bf16 a[228:231], a[224:227], v[128:131], 0
    s_waitcnt lgkmcnt(4)
    v_mfma_f32_32x32x16_bf16 v[64:79], v[48:51], v[132:135], v[64:79]
    ds_read_b64_tr_b16 v[40:41], v18 offset:0
    ds_read_b64_tr_b16 v[42:43], v18 offset:512
    buffer_load_dwordx4 v6, s[4:7], s51 offen offset:2304 lds
    v_mfma_f32_32x32x16_bf16 v[80:95], v[52:55], v[132:135], v[80:95]
    ds_read_b64_tr_b16 v[44:45], v19 offset:0
    ds_read_b64_tr_b16 v[46:47], v19 offset:512
    s_waitcnt vmcnt(10)
    ds_read_b128 v[144:147], v8 offset:16384
    v_mfma_f32_16x16x32_bf16 a[228:231], a[224:227], v[132:135], a[228:231]
    s_waitcnt lgkmcnt(5)
    v_mfma_f32_32x32x16_bf16 v[64:79], v[56:59], v[136:139], v[64:79]
    s_waitcnt vmcnt(7)
    ds_read_b64_tr_b16 v[48:49], v12 offset:2048
    ds_read_b64_tr_b16 v[50:51], v12 offset:2560
    ds_read_b128 v[148:151], v9 offset:16384
    buffer_load_dwordx4 v7, s[4:7], s52 offen offset:3328 lds
    s_add_u32 m0, s54, 16384
    v_mfma_f32_32x32x16_bf16 v[80:95], v[60:63], v[136:139], v[80:95]
    ds_read_b64_tr_b16 v[52:53], v13 offset:2048
    ds_read_b64_tr_b16 v[54:55], v13 offset:2560
    ds_read_b128 v[152:155], v10 offset:16384
    buffer_load_dwordx4 v4, s[24:27], s53 offen lds
    v_mfma_f32_16x16x32_bf16 a[228:231], a[224:227], v[136:139], a[228:231]
    s_waitcnt lgkmcnt(7)
    v_mfma_f32_32x32x16_bf16 v[64:79], v[40:43], v[140:143], v[64:79]
    s_barrier
    ds_read_b64_tr_b16 v[56:57], v14 offset:2048
    ds_read_b64_tr_b16 v[58:59], v14 offset:2560
    ds_read_b128 v[156:159], v11 offset:16384
    buffer_load_dwordx4 v5, s[24:27], s53 offen offset:1024 lds
    s_add_u32 s53, s53, 229376
    s_add_u32 m0, s54, 114304
    v_mfma_f32_32x32x16_bf16 v[80:95], v[44:47], v[140:143], v[80:95]
    ds_read_b64_tr_b16 v[60:61], v15 offset:2048
    ds_read_b64_tr_b16 v[62:63], v15 offset:2560
    v_mfma_f32_16x16x32_bf16 a[228:231], a[224:227], v[140:143], a[228:231]
    s_waitcnt lgkmcnt(6)
    v_mfma_f32_32x32x16_bf16 v[64:79], v[48:51], v[144:147], v[64:79]
    ds_read_b64_tr_b16 v[40:41], v16 offset:2048
    ds_read_b64_tr_b16 v[42:43], v16 offset:2560
    buffer_load_dwordx4 v6, s[4:7], s49 offen offset:384 lds
    v_mfma_f32_16x16x32_bf16 a[232:235], a[224:227], v[48:51], a[232:235]
    v_mfma_f32_32x32x16_bf16 v[80:95], v[52:55], v[144:147], v[80:95]
    ds_read_b64_tr_b16 v[44:45], v17 offset:2048
    ds_read_b64_tr_b16 v[46:47], v17 offset:2560
    buffer_load_dwordx4 v7, s[4:7], s50 offen offset:1408 lds
    v_mfma_f32_16x16x32_bf16 a[236:239], a[224:227], v[52:55], a[236:239]
    v_mfma_f32_16x16x32_bf16 a[228:231], a[224:227], v[144:147], a[228:231]
    s_waitcnt lgkmcnt(4)
    v_mfma_f32_32x32x16_bf16 v[64:79], v[56:59], v[148:151], v[64:79]
    ds_read_b64_tr_b16 v[48:49], v18 offset:2048
    ds_read_b64_tr_b16 v[50:51], v18 offset:2560
    buffer_load_dwordx4 v6, s[4:7], s51 offen offset:2432 lds
    v_mfma_f32_32x32x16_bf16 v[80:95], v[60:63], v[148:151], v[80:95]
    ds_read_b64_tr_b16 v[52:53], v19 offset:2048
    ds_read_b64_tr_b16 v[54:55], v19 offset:2560
    v_mfma_f32_16x16x32_bf16 a[228:231], a[224:227], v[148:151], a[228:231]
    s_waitcnt lgkmcnt(4)
    v_mfma_f32_32x32x16_bf16 v[64:79], v[40:43], v[152:155], v[64:79]
    buffer_load_dwordx4 v7, s[4:7], s52 offen offset:3456 lds
    s_add_u32 m0, s54, 18432
    v_mfma_f32_32x32x16_bf16 v[80:95], v[44:47], v[152:155], v[80:95]
    buffer_load_dwordx4 v4, s[24:27], s53 offen lds
    s_waitcnt vmcnt(11)
    v_mfma_f32_16x16x32_bf16 a[228:231], a[224:227], v[152:155], a[228:231]
    s_waitcnt lgkmcnt(0)
    v_mfma_f32_32x32x16_bf16 v[64:79], v[48:51], v[156:159], v[64:79]
    s_barrier
    buffer_load_dwordx4 v5, s[24:27], s53 offen offset:1024 lds
    s_add_u32 s53, s53, 229376
    s_add_u32 m0, s54, 65024
    v_mfma_f32_32x32x16_bf16 v[80:95], v[52:55], v[156:159], v[80:95]
    v_mfma_f32_16x16x32_bf16 a[228:231], a[224:227], v[156:159], a[228:231]
    ds_read_b64_tr_b16 v[192:193], v255 offset:128
    ds_read_b64_tr_b16 v[194:195], v255 offset:256
    ds_read_b64_tr_b16 v[196:197], v255 offset:384
    ds_read_b64_tr_b16 v[198:199], v254 offset:0
    ds_read_b64_tr_b16 v[200:201], v254 offset:128
    ds_read_b64_tr_b16 v[202:203], v254 offset:256
    ds_read_b64_tr_b16 v[204:205], v254 offset:384
    ds_read_b64_tr_b16 v[206:207], v254 offset:8192
    ds_read_b64_tr_b16 v[208:209], v254 offset:8320
    ds_read_b64_tr_b16 v[210:211], v254 offset:8448
    ds_read_b64_tr_b16 v[212:213], v254 offset:8576
    v_lshlrev_b32 v112, 16, v124
    v_and_b32 v113, 0xffff0000, v124
    v_lshlrev_b32 v114, 16, v125
    v_and_b32 v115, 0xffff0000, v125
    s_add_u32 s42, s42, 0x7f4a7c15
    s_addc_u32 s43, s43, 0x9e3779b9
    v_mov_b32 v22, s42
    v_mov_b32 v23, s43
    s_waitcnt lgkmcnt(10)
    v_lshlrev_b32 v214, 16, v192
    v_and_b32 v215, 0xffff0000, v192
    v_lshlrev_b32 v216, 16, v193
    buffer_load_dwordx4 v[96:99], v2, s[20:23], s73 offen offset:0
    v_and_b32 v217, 0xffff0000, v193
    s_waitcnt lgkmcnt(9)
    v_lshlrev_b32 v218, 16, v194
    v_and_b32 v219, 0xffff0000, v194
    v_lshlrev_b32 v220, 16, v195
    v_and_b32 v221, 0xffff0000, v195
    s_waitcnt lgkmcnt(8)
    v_lshlrev_b32 v222, 16, v196
    v_and_b32 v223, 0xffff0000, v196
    v_lshlrev_b32 v224, 16, v197
    v_and_b32 v225, 0xffff0000, v197
    buffer_load_dwordx4 v[100:103], v2, s[20:23], s73 offen offset:1024
    s_waitcnt lgkmcnt(7)
    v_lshlrev_b32 v226, 16, v198
    v_and_b32 v227, 0xffff0000, v198
    v_lshlrev_b32 v228, 16, v199
    v_and_b32 v229, 0xffff0000, v199
    s_waitcnt lgkmcnt(3)
    v_lshlrev_b32 v242, 16, v206
    v_and_b32 v243, 0xffff0000, v206
    v_lshlrev_b32 v244, 16, v207
    v_and_b32 v245, 0xffff0000, v207
    v_pk_mul_f32 v[250:251], v[214:215], v[114:115] op_sel:[0,1] op_sel_hi:[1,1]
    buffer_load_dwordx4 v[104:107], v2, s[20:23], s73 offen offset:2048
    v_pk_mul_f32 v[252:253], v[216:217], v[114:115] op_sel:[0,1] op_sel_hi:[1,1]
    v_pk_fma_f32 v[250:251], v[218:219], v[114:115], v[250:251] op_sel:[0,0,0] op_sel_hi:[1,0,1]
    v_pk_fma_f32 v[252:253], v[220:221], v[114:115], v[252:253] op_sel:[0,0,0] op_sel_hi:[1,0,1]
    v_pk_fma_f32 v[250:251], v[222:223], v[112:113], v[250:251] op_sel:[0,1,0] op_sel_hi:[1,1,1]
    v_pk_fma_f32 v[252:253], v[224:225], v[112:113], v[252:253] op_sel:[0,1,0] op_sel_hi:[1,1,1]
    v_pk_fma_f32 v[250:251], v[226:227], v[112:113], v[250:251] op_sel:[0,0,0] op_sel_hi:[1,0,1]
    v_pk_fma_f32 v[252:253], v[228:229], v[112:113], v[252:253] op_sel:[0,0,0] op_sel_hi:[1,0,1]
    v_pk_mul_f32 v[250:251], v[250:251], v[242:243]
    v_pk_mul_f32 v[252:253], v[252:253], v[244:245]
    buffer_load_dwordx4 v[108:111], v2, s[20:23], s73 offen offset:3072
    v_cvt_pk_bf16_f32 v116, v250, v251
    v_cvt_pk_bf16_f32 v117, v252, v253
    v_lshlrev_b32 v230, 16, v200
    v_and_b32 v231, 0xffff0000, v200
    v_lshlrev_b32 v232, 16, v201
    v_and_b32 v233, 0xffff0000, v201
    s_waitcnt lgkmcnt(2)
    v_lshlrev_b32 v246, 16, v208
    v_and_b32 v247, 0xffff0000, v208
    v_lshlrev_b32 v248, 16, v209
    buffer_load_dwordx4 v6, s[4:7], s49 offen offset:512 lds
    v_and_b32 v249, 0xffff0000, v209
    v_pk_mul_f32 v[250:251], v[218:219], v[114:115] op_sel:[0,1] op_sel_hi:[1,1]
    v_pk_mul_f32 v[252:253], v[220:221], v[114:115] op_sel:[0,1] op_sel_hi:[1,1]
    v_pk_fma_f32 v[250:251], v[222:223], v[114:115], v[250:251] op_sel:[0,0,0] op_sel_hi:[1,0,1]
    v_pk_fma_f32 v[252:253], v[224:225], v[114:115], v[252:253] op_sel:[0,0,0] op_sel_hi:[1,0,1]
    v_pk_fma_f32 v[250:251], v[226:227], v[112:113], v[250:251] op_sel:[0,1,0] op_sel_hi:[1,1,1]
    v_pk_fma_f32 v[252:253], v[228:229], v[112:113], v[252:253] op_sel:[0,1,0] op_sel_hi:[1,1,1]
    v_pk_fma_f32 v[250:251], v[230:231], v[112:113], v[250:251] op_sel:[0,0,0] op_sel_hi:[1,0,1]
    v_pk_fma_f32 v[252:253], v[232:233], v[112:113], v[252:253] op_sel:[0,0,0] op_sel_hi:[1,0,1]
    v_pk_mul_f32 v[250:251], v[250:251], v[246:247]
    buffer_load_dwordx4 v7, s[4:7], s50 offen offset:1536 lds
    v_pk_mul_f32 v[252:253], v[252:253], v[248:249]
    v_cvt_pk_bf16_f32 v118, v250, v251
    v_cvt_pk_bf16_f32 v119, v252, v253
    ds_write_b128 v126, v[116:119]
    v_lshlrev_b32 v234, 16, v202
    v_and_b32 v235, 0xffff0000, v202
    v_lshlrev_b32 v236, 16, v203
    v_and_b32 v237, 0xffff0000, v203
    s_waitcnt lgkmcnt(2)
    v_lshlrev_b32 v242, 16, v210
    buffer_load_dwordx4 v6, s[4:7], s51 offen offset:2560 lds
    v_and_b32 v243, 0xffff0000, v210
    v_lshlrev_b32 v244, 16, v211
    v_and_b32 v245, 0xffff0000, v211
    v_pk_mul_f32 v[250:251], v[222:223], v[114:115] op_sel:[0,1] op_sel_hi:[1,1]
    v_pk_mul_f32 v[252:253], v[224:225], v[114:115] op_sel:[0,1] op_sel_hi:[1,1]
    v_pk_fma_f32 v[250:251], v[226:227], v[114:115], v[250:251] op_sel:[0,0,0] op_sel_hi:[1,0,1]
    v_pk_fma_f32 v[252:253], v[228:229], v[114:115], v[252:253] op_sel:[0,0,0] op_sel_hi:[1,0,1]
    v_pk_fma_f32 v[250:251], v[230:231], v[112:113], v[250:251] op_sel:[0,1,0] op_sel_hi:[1,1,1]
    v_pk_fma_f32 v[252:253], v[232:233], v[112:113], v[252:253] op_sel:[0,1,0] op_sel_hi:[1,1,1]
    buffer_load_dwordx4 v7, s[4:7], s52 offen offset:3584 lds
    s_add_u32 m0, s54, 32768
    v_pk_fma_f32 v[250:251], v[234:235], v[112:113], v[250:251] op_sel:[0,0,0] op_sel_hi:[1,0,1]
    v_pk_fma_f32 v[252:253], v[236:237], v[112:113], v[252:253] op_sel:[0,0,0] op_sel_hi:[1,0,1]
    v_pk_mul_f32 v[250:251], v[250:251], v[242:243]
    v_pk_mul_f32 v[252:253], v[252:253], v[244:245]
    v_cvt_pk_bf16_f32 v120, v250, v251
    v_cvt_pk_bf16_f32 v121, v252, v253
    v_lshlrev_b32 v238, 16, v204
    v_and_b32 v239, 0xffff0000, v204
    v_lshlrev_b32 v240, 16, v205
    buffer_load_dwordx4 v4, s[24:27], s53 offen lds
    v_and_b32 v241, 0xffff0000, v205
    s_waitcnt lgkmcnt(1)
    v_lshlrev_b32 v246, 16, v212
    v_and_b32 v247, 0xffff0000, v212
    v_lshlrev_b32 v248, 16, v213
    v_and_b32 v249, 0xffff0000, v213
    v_pk_mul_f32 v[250:251], v[226:227], v[114:115] op_sel:[0,1] op_sel_hi:[1,1]
    v_pk_mul_f32 v[252:253], v[228:229], v[114:115] op_sel:[0,1] op_sel_hi:[1,1]
    v_pk_fma_f32 v[250:251], v[230:231], v[114:115], v[250:251] op_sel:[0,0,0] op_sel_hi:[1,0,1]
    v_pk_fma_f32 v[252:253], v[232:233], v[114:115], v[252:253] op_sel:[0,0,0] op_sel_hi:[1,0,1]
    buffer_load_dwordx4 v5, s[24:27], s53 offen offset:1024 lds
    s_add_u32 s53, s53, 229376
    s_add_u32 m0, s54, 81280
    v_pk_fma_f32 v[250:251], v[234:235], v[112:113], v[250:251] op_sel:[0,1,0] op_sel_hi:[1,1,1]
    v_pk_fma_f32 v[252:253], v[236:237], v[112:113], v[252:253] op_sel:[0,1,0] op_sel_hi:[1,1,1]
    v_pk_fma_f32 v[250:251], v[238:239], v[112:113], v[250:251] op_sel:[0,0,0] op_sel_hi:[1,0,1]
    v_pk_fma_f32 v[252:253], v[240:241], v[112:113], v[252:253] op_sel:[0,0,0] op_sel_hi:[1,0,1]
    v_pk_mul_f32 v[250:251], v[250:251], v[246:247]
    v_pk_mul_f32 v[252:253], v[252:253], v[248:249]
    v_cvt_pk_bf16_f32 v122, v250, v251
    v_cvt_pk_bf16_f32 v123, v252, v253
    ds_write_b128 v127, v[120:123]
    ds_read_b128 v[116:119], v24
    ds_read_b128 v[120:123], v24 offset:1088
    s_waitcnt vmcnt(18)
    ds_read_b128 v[160:163], v8 offset:32768
    ds_read_b128 v[164:167], v9 offset:32768
    ds_read_b128 v[168:171], v10 offset:32768
    ds_read_b128 v[172:175], v11 offset:32768
    s_waitcnt vmcnt(16)
    s_barrier
    ds_read_b64_tr_b16 v[56:57], v12 offset:16384
    ds_read_b64_tr_b16 v[58:59], v12 offset:16896
    ds_read_b64_tr_b16 v[60:61], v13 offset:16384
    ds_read_b64_tr_b16 v[62:63], v13 offset:16896
    ds_read_b64_tr_b16 v[40:41], v14 offset:16384
    ds_read_b64_tr_b16 v[42:43], v14 offset:16896
    ds_read_b64_tr_b16 v[44:45], v15 offset:16384
    ds_read_b64_tr_b16 v[46:47], v15 offset:16896
    s_waitcnt lgkmcnt(4)
    v_mfma_f32_32x32x16_bf16 v[64:79], v[56:59], v[160:163], v[64:79]
    ds_read_b64_tr_b16 v[48:49], v16 offset:16384
    ds_read_b64_tr_b16 v[50:51], v16 offset:16896
    buffer_load_dwordx4 v6, s[4:7], s49 offen offset:640 lds
    v_mfma_f32_16x16x32_bf16 a[232:235], a[224:227], v[56:59], a[232:235]
    v_mfma_f32_32x32x16_bf16 v[80:95], v[60:63], v[160:163], v[80:95]
    ds_read_b64_tr_b16 v[52:53], v17 offset:16384
    ds_read_b64_tr_b16 v[54:55], v17 offset:16896
    s_waitcnt vmcnt(13)
    ds_read_b128 v[176:179], v8 offset:49152
    buffer_load_dwordx4 v7, s[4:7], s50 offen offset:1664 lds
    v_mfma_f32_16x16x32_bf16 a[236:239], a[224:227], v[60:63], a[236:239]
    v_mfma_f32_16x16x32_bf16 a[228:231], a[224:227], v[160:163], a[228:231]
    s_waitcnt lgkmcnt(5)
    v_mfma_f32_32x32x16_bf16 v[64:79], v[40:43], v[164:167], v[64:79]
    ds_read_b64_tr_b16 v[56:57], v18 offset:16384
    ds_read_b64_tr_b16 v[58:59], v18 offset:16896
    ds_read_b128 v[180:183], v9 offset:49152
    buffer_load_dwordx4 v6, s[4:7], s51 offen offset:2688 lds
    v_mfma_f32_32x32x16_bf16 v[80:95], v[44:47], v[164:167], v[80:95]
    ds_read_b64_tr_b16 v[60:61], v19 offset:16384
    ds_read_b64_tr_b16 v[62:63], v19 offset:16896
    ds_read_b128 v[184:187], v10 offset:49152
    buffer_load_dwordx4 v7, s[4:7], s52 offen offset:3712 lds
    s_add_u32 m0, s54, 34816
    v_mfma_f32_16x16x32_bf16 a[228:231], a[224:227], v[164:167], a[228:231]
    s_waitcnt lgkmcnt(7)
    v_mfma_f32_32x32x16_bf16 v[64:79], v[48:51], v[168:171], v[64:79]
    s_waitcnt vmcnt(14)
    ds_read_b64_tr_b16 v[40:41], v12 offset:18432
    ds_read_b64_tr_b16 v[42:43], v12 offset:18944
    ds_read_b128 v[188:191], v11 offset:49152
    v_mfma_f32_32x32x16_bf16 v[80:95], v[52:55], v[168:171], v[80:95]
    ds_read_b64_tr_b16 v[44:45], v13 offset:18432
    ds_read_b64_tr_b16 v[46:47], v13 offset:18944
    buffer_load_dwordx4 v4, s[24:27], s53 offen lds
    v_mfma_f32_16x16x32_bf16 a[228:231], a[224:227], v[168:171], a[228:231]
    s_waitcnt lgkmcnt(6)
    v_mfma_f32_32x32x16_bf16 v[64:79], v[56:59], v[172:175], v[64:79]
    s_barrier
    ds_read_b64_tr_b16 v[48:49], v14 offset:18432
    ds_read_b64_tr_b16 v[50:51], v14 offset:18944
    buffer_load_dwordx4 v5, s[24:27], s53 offen offset:1024 lds
    s_add_u32 s53, s53, 229376
    s_add_u32 m0, s54, 97536
    v_mfma_f32_32x32x16_bf16 v[80:95], v[60:63], v[172:175], v[80:95]
    ds_read_b64_tr_b16 v[52:53], v15 offset:18432
    ds_read_b64_tr_b16 v[54:55], v15 offset:18944
    buffer_load_dwordx4 v6, s[4:7], s49 offen offset:768 lds
    v_mfma_f32_16x16x32_bf16 a[228:231], a[224:227], v[172:175], a[228:231]
    s_waitcnt lgkmcnt(4)
    v_mfma_f32_32x32x16_bf16 v[64:79], v[40:43], v[176:179], v[64:79]
    ds_read_b64_tr_b16 v[56:57], v16 offset:18432
    ds_read_b64_tr_b16 v[58:59], v16 offset:18944
    s_waitcnt vmcnt(9)
    ds_read_b128 v[192:195], v8 offset:0
    buffer_load_dwordx4 v7, s[4:7], s50 offen offset:1792 lds
    v_mfma_f32_16x16x32_bf16 a[232:235], a[224:227], v[40:43], a[232:235]
    v_mfma_f32_32x32x16_bf16 v[80:95], v[44:47], v[176:179], v[80:95]
    ds_read_b64_tr_b16 v[60:61], v17 offset:18432
    ds_read_b64_tr_b16 v[62:63], v17 offset:18944
    ds_read_b128 v[196:199], v9 offset:0
    v_mfma_f32_16x16x32_bf16 a[236:239], a[224:227], v[44:47], a[236:239]
    v_mfma_f32_16x16x32_bf16 a[228:231], a[224:227], v[176:179], a[228:231]
    s_waitcnt lgkmcnt(6)
    v_mfma_f32_32x32x16_bf16 v[64:79], v[48:51], v[180:183], v[64:79]
    ds_read_b64_tr_b16 v[40:41], v18 offset:18432
    ds_read_b64_tr_b16 v[42:43], v18 offset:18944
    ds_read_b128 v[200:203], v10 offset:0
    buffer_load_dwordx4 v6, s[4:7], s51 offen offset:2816 lds
    v_mfma_f32_32x32x16_bf16 v[80:95], v[52:55], v[180:183], v[80:95]
    ds_read_b64_tr_b16 v[44:45], v19 offset:18432
    ds_read_b64_tr_b16 v[46:47], v19 offset:18944
    ds_read_b128 v[204:207], v11 offset:0
    buffer_load_dwordx4 v7, s[4:7], s52 offen offset:3840 lds
    s_add_u32 m0, s54, 49152
    v_mfma_f32_16x16x32_bf16 a[228:231], a[224:227], v[180:183], a[228:231]
    s_waitcnt lgkmcnt(7)
    v_mfma_f32_32x32x16_bf16 v[64:79], v[56:59], v[184:187], v[64:79]
    s_waitcnt vmcnt(10)
    ds_read_b64_tr_b16 v[48:49], v12 offset:32768
    ds_read_b64_tr_b16 v[50:51], v12 offset:33280
    buffer_load_dwordx4 v4, s[24:27], s53 offen lds
    v_mfma_f32_32x32x16_bf16 v[80:95], v[60:63], v[184:187], v[80:95]
    ds_read_b64_tr_b16 v[52:53], v13 offset:32768
    ds_read_b64_tr_b16 v[54:55], v13 offset:33280
    buffer_load_dwordx4 v5, s[24:27], s53 offen offset:1024 lds
    s_add_u32 s53, s53, 229376
    s_add_u32 m0, s54, 113792
    v_mfma_f32_16x16x32_bf16 a[228:231], a[224:227], v[184:187], a[228:231]
    s_waitcnt lgkmcnt(5)
    v_mfma_f32_32x32x16_bf16 v[64:79], v[40:43], v[188:191], v[64:79]
    s_barrier
    ds_read_b64_tr_b16 v[56:57], v14 offset:32768
    ds_read_b64_tr_b16 v[58:59], v14 offset:33280
    v_mfma_f32_32x32x16_bf16 v[80:95], v[44:47], v[188:191], v[80:95]
    ds_read_b64_tr_b16 v[60:61], v15 offset:32768
    ds_read_b64_tr_b16 v[62:63], v15 offset:33280
    s_waitcnt vmcnt(8)
    ds_read_b128 v[208:211], v8 offset:16384
    buffer_load_dwordx4 v6, s[4:7], s49 offen offset:896 lds
    v_mfma_f32_16x16x32_bf16 a[228:231], a[224:227], v[188:191], a[228:231]
    s_branch L_over1
L_page1:
    s_branch L_ret
L_over1:
    s_waitcnt lgkmcnt(5)
    v_mfma_f32_32x32x16_bf16 v[64:79], v[48:51], v[192:195], v[64:79]
    ds_read_b64_tr_b16 v[40:41], v16 offset:32768
    ds_read_b64_tr_b16 v[42:43], v16 offset:33280
    ds_read_b128 v[212:215], v9 offset:16384
    buffer_load_dwordx4 v7, s[4:7], s50 offen offset:1920 lds
    v_mfma_f32_16x16x32_bf16 a[232:235], a[224:227], v[48:51], a[232:235]
    v_mfma_f32_32x32x16_bf16 v[80:95], v[52:55], v[192:195], v[80:95]
    ds_read_b64_tr_b16 v[44:45], v17 offset:32768
    ds_read_b64_tr_b16 v[46:47], v17 offset:33280
    ds_read_b128 v[216:219], v10 offset:16384
    buffer_load_dwordx4 v6, s[4:7], s51 offen offset:2944 lds
    v_mfma_f32_16x16x32_bf16 a[236:239], a[224:227], v[52:55], a[236:239]
    v_mfma_f32_16x16x32_bf16 a[228:231], a[224:227], v[192:195], a[228:231]
    s_waitcnt lgkmcnt(7)
    v_mfma_f32_32x32x16_bf16 v[64:79], v[56:59], v[196:199], v[64:79]
    ds_read_b64_tr_b16 v[48:49], v18 offset:32768
    ds_read_b64_tr_b16 v[50:51], v18 offset:33280
    ds_read_b128 v[220:223], v11 offset:16384
    buffer_load_dwordx4 v7, s[4:7], s52 offen offset:3968 lds
    s_add_u32 m0, s54, 51200
    v_mfma_f32_32x32x16_bf16 v[80:95], v[60:63], v[196:199], v[80:95]
    ds_read_b64_tr_b16 v[52:53], v19 offset:32768
    ds_read_b64_tr_b16 v[54:55], v19 offset:33280
    buffer_load_dwordx4 v4, s[24:27], s53 offen lds
    v_mfma_f32_16x16x32_bf16 a[228:231], a[224:227], v[196:199], a[228:231]
    s_waitcnt lgkmcnt(6)
    v_mfma_f32_32x32x16_bf16 v[64:79], v[40:43], v[200:203], v[64:79]
    s_waitcnt vmcnt(11)
    ds_read_b64_tr_b16 v[56:57], v12 offset:34816
    ds_read_b64_tr_b16 v[58:59], v12 offset:35328
    v_mfma_f32_32x32x16_bf16 v[80:95], v[44:47], v[200:203], v[80:95]
    ds_read_b64_tr_b16 v[60:61], v13 offset:34816
    ds_read_b64_tr_b16 v[62:63], v13 offset:35328
    buffer_load_dwordx4 v5, s[24:27], s53 offen offset:1024 lds
    s_add_u32 s53, s53, 4293361792
    s_add_u32 m0, s54, 65536
    v_mfma_f32_16x16x32_bf16 a[228:231], a[224:227], v[200:203], a[228:231]
    s_waitcnt lgkmcnt(4)
    v_mfma_f32_32x32x16_bf16 v[64:79], v[48:51], v[204:207], v[64:79]
    s_barrier
    ds_read_b64_tr_b16 v[40:41], v14 offset:34816
    ds_read_b64_tr_b16 v[42:43], v14 offset:35328
    buffer_store_dwordx4 v[116:119], v38, s[36:39], s99 offen sc1
    v_mfma_f32_32x32x16_bf16 v[80:95], v[52:55], v[204:207], v[80:95]
    ds_read_b64_tr_b16 v[44:45], v15 offset:34816
    ds_read_b64_tr_b16 v[46:47], v15 offset:35328
    buffer_store_dwordx4 v[120:123], v38, s[36:39], s100 offen sc1
    v_mfma_f32_16x16x32_bf16 a[228:231], a[224:227], v[204:207], a[228:231]
    s_waitcnt lgkmcnt(4)
    v_mfma_f32_32x32x16_bf16 v[64:79], v[56:59], v[208:211], v[64:79]
    ds_read_b64_tr_b16 v[48:49], v16 offset:34816
    ds_read_b64_tr_b16 v[50:51], v16 offset:35328
    s_waitcnt vmcnt(10)
    ds_read_b128 v[224:227], v8 offset:32768
    buffer_load_dwordx4 v4, s[24:27], s53 offen lds
    s_lshr_b32 s60, s44, 1
    s_lshl_b32 s60, s60, 4
    s_lshr_b32 s60, s56, s60
    s_lshl_b32 s60, s60, 16
    s_lshl_b32 s61, s58, 16
    v_mov_b32 v112, s60
    v_mfma_f32_16x16x32_bf16 a[232:235], a[224:227], v[56:59], a[232:235]
    v_mfma_f32_32x32x16_bf16 v[80:95], v[60:63], v[208:211], v[80:95]
    ds_read_b64_tr_b16 v[52:53], v17 offset:34816
    ds_read_b64_tr_b16 v[54:55], v17 offset:35328
    ds_read_b128 v[228:231], v9 offset:32768
    buffer_load_dwordx4 v5, s[24:27], s53 offen offset:1024 lds
    s_add_u32 s53, s53, 229376
    s_add_u32 m0, s54, 67584
    v_add_f32 v112, s61, v112
    v_cvt_pk_bf16_f32 v112, v112, v112
    s_mul_i32 s62, s44, 8256
    v_mov_b32 v116, 0
    v_readfirstlane_b32 s60, v112
    v_mov_b32 v117, 0
    v_mfma_f32_16x16x32_bf16 a[236:239], a[224:227], v[60:63], a[236:239]
    v_mfma_f32_16x16x32_bf16 a[228:231], a[224:227], v[208:211], a[228:231]
    s_waitcnt lgkmcnt(6)
    v_mfma_f32_32x32x16_bf16 v[64:79], v[40:43], v[212:215], v[64:79]
    ds_read_b64_tr_b16 v[56:57], v18 offset:34816
    ds_read_b64_tr_b16 v[58:59], v18 offset:35328
    ds_read_b128 v[232:235], v10 offset:32768
    v_mov_b32 v118, 0
    v_mov_b32 v119, 0
    s_and_b32 s60, s60, 0xffff
    s_and_b32 s61, s58, 0xffff0000
    s_or_b32 s60, s60, s61
    s_bitcmp1_b32 s44, 0
    s_cselect_b32 s57, s60, s59
    s_cselect_b32 s60, 0, s60
    v_mfma_f32_32x32x16_bf16 v[80:95], v[44:47], v[212:215], v[80:95]
    ds_read_b64_tr_b16 v[60:61], v19 offset:34816
    ds_read_b64_tr_b16 v[62:63], v19 offset:35328
    ds_read_b128 v[236:239], v11 offset:32768
    buffer_load_dwordx4 v4, s[24:27], s53 offen lds
    s_lshl_b32 s61, s60, 16
    s_lshl_b32 s63, s57, 16
    v_writelane_b32 v118, s60, 1
    s_lshr_b32 s60, s60, 16
    v_writelane_b32 v119, s57, 1
    s_or_b32 s63, s63, s60
    s_lshl3_add_u32 s40, s44, s48
    s_lshl_b32 s40, s40, 7
    v_mfma_f32_16x16x32_bf16 a[228:231], a[224:227], v[212:215], a[228:231]
    s_waitcnt lgkmcnt(7)
    v_mfma_f32_32x32x16_bf16 v[64:79], v[48:51], v[216:219], v[64:79]
    s_waitcnt vmcnt(11)
    ds_read_b64_tr_b16 v[40:41], v12 offset:49152
    ds_read_b64_tr_b16 v[42:43], v12 offset:49664
    buffer_load_dwordx4 v5, s[24:27], s53 offen offset:1024 lds
    s_add_u32 s53, s53, 229376
    s_add_u32 m0, s54, 81920
    v_writelane_b32 v118, s61, 3
    v_writelane_b32 v119, s63, 3
    v_and_b32 v112, 1, v1
    v_lshrrev_b32 v113, 1, v1
    v_mul_u32_u24 v113, 4128, v113
    v_lshl_add_u32 v112, v112, 4, v113
    s_add_u32 s40, s40, 13004800
    v_mov_b32 v26, 0
    v_mfma_f32_32x32x16_bf16 v[80:95], v[52:55], v[216:219], v[80:95]
    ds_read_b64_tr_b16 v[44:45], v13 offset:49152
    ds_read_b64_tr_b16 v[46:47], v13 offset:49664
    buffer_load_dwordx2 v[24:25], v26, s[36:39], s40 offen offset:0 sc1
    v_add_u32 v112, s62, v112
    v_add_u32 v114, s62, v2
    v_lshlrev_b32 v113, 2, v0
    v_mfma_f32_16x16x32_bf16 a[228:231], a[224:227], v[216:219], a[228:231]
    s_waitcnt lgkmcnt(5)
    v_mfma_f32_32x32x16_bf16 v[64:79], v[56:59], v[220:223], v[64:79]
    s_barrier
    ds_read_b64_tr_b16 v[48:49], v14 offset:49152
    ds_read_b64_tr_b16 v[50:51], v14 offset:49664
    buffer_load_dwordx4 v4, s[24:27], s53 offen lds
    v_mov_b32 v115, s57
    v_readlane_b32 s57, v99, 63
    v_alignbyte_b32 v121, v97, v96, 2
    v_mfma_f32_32x32x16_bf16 v[80:95], v[60:63], v[220:223], v[80:95]
    ds_read_b64_tr_b16 v[52:53], v15 offset:49152
    ds_read_b64_tr_b16 v[54:55], v15 offset:49664
    buffer_load_dwordx4 v5, s[24:27], s53 offen offset:1024 lds
    s_add_u32 s53, s53, 229376
    s_add_u32 m0, s54, 83968
    v_mov_b32_dpp v115, v99 wave_shr:1 row_mask:0xf bank_mask:0xf
    v_alignbyte_b32 v122, v98, v97, 2
    v_alignbyte_b32 v123, v99, v98, 2
    v_mfma_f32_16x16x32_bf16 a[228:231], a[224:227], v[220:223], a[228:231]
    s_waitcnt lgkmcnt(4)
    v_mfma_f32_32x32x16_bf16 v[64:79], v[40:43], v[224:227], v[64:79]
    ds_read_b64_tr_b16 v[56:57], v16 offset:49152
    ds_read_b64_tr_b16 v[58:59], v16 offset:49664
    s_waitcnt vmcnt(11)
    ds_read_b128 v[240:243], v8 offset:49152
    v_alignbyte_b32 v120, v96, v115, 2
    v_mov_b32 v115, s57
    v_readlane_b32 s57, v103, 63
    v_mfma_f32_16x16x32_bf16 a[232:235], a[224:227], v[40:43], a[232:235]
    v_mfma_f32_32x32x16_bf16 v[80:95], v[44:47], v[224:227], v[80:95]
    ds_read_b64_tr_b16 v[60:61], v17 offset:49152
    ds_read_b64_tr_b16 v[62:63], v17 offset:49664
    ds_read_b128 v[244:247], v9 offset:49152
    buffer_load_dwordx4 v4, s[24:27], s53 offen lds
    v_alignbyte_b32 v125, v101, v100, 2
    v_mov_b32_dpp v115, v103 wave_shr:1 row_mask:0xf bank_mask:0xf
    v_alignbyte_b32 v126, v102, v101, 2
    v_mfma_f32_16x16x32_bf16 a[236:239], a[224:227], v[44:47], a[236:239]
    v_mfma_f32_16x16x32_bf16 a[228:231], a[224:227], v[224:227], a[228:231]
    s_waitcnt lgkmcnt(6)
    v_mfma_f32_32x32x16_bf16 v[64:79], v[48:51], v[228:231], v[64:79]
    ds_read_b64_tr_b16 v[40:41], v18 offset:49152
    ds_read_b64_tr_b16 v[42:43], v18 offset:49664
    ds_read_b128 v[248:251], v10 offset:49152
    buffer_load_dwordx4 v5, s[24:27], s53 offen offset:1024 lds
    s_add_u32 s53, s53, 229376
    s_add_u32 m0, s54, 98304
    v_alignbyte_b32 v127, v103, v102, 2
    v_alignbyte_b32 v124, v100, v115, 2
    v_mfma_f32_32x32x16_bf16 v[80:95], v[52:55], v[228:231], v[80:95]
    ds_read_b64_tr_b16 v[44:45], v19 offset:49152
    ds_read_b64_tr_b16 v[46:47], v19 offset:49664
    ds_read_b128 v[252:255], v11 offset:49152
    buffer_load_dwordx4 v4, s[24:27], s53 offen lds
    s_mov_b64 exec, 15
    ds_write_b128 v112, v[116:119] offset:0
    s_mov_b64 exec, -1
    v_mfma_f32_16x16x32_bf16 a[228:231], a[224:227], v[228:231], a[228:231]
    s_waitcnt lgkmcnt(8)
    v_mfma_f32_32x32x16_bf16 v[64:79], v[56:59], v[232:235], v[64:79]
    s_waitcnt vmcnt(12)
    ds_read_b64_tr_b16 v[48:49], v12 offset:51200
    ds_read_b64_tr_b16 v[50:51], v12 offset:51712
    buffer_load_dwordx4 v5, s[24:27], s53 offen offset:1024 lds
    s_add_u32 s53, s53, 229376
    s_add_u32 m0, s54, 100352
    ds_write_b32 v113, v116 offset:33280
    v_mfma_f32_32x32x16_bf16 v[80:95], v[60:63], v[232:235], v[80:95]
    ds_read_b64_tr_b16 v[52:53], v13 offset:51200
    ds_read_b64_tr_b16 v[54:55], v13 offset:51712
    buffer_load_dwordx4 v4, s[24:27], s53 offen lds
    s_waitcnt vmcnt(12)
    ds_write_b128 v114, v[96:99] offset:32
    v_mfma_f32_16x16x32_bf16 a[228:231], a[224:227], v[232:235], a[228:231]
    s_waitcnt lgkmcnt(8)
    v_mfma_f32_32x32x16_bf16 v[64:79], v[40:43], v[236:239], v[64:79]
    s_barrier
    ds_read_b64_tr_b16 v[56:57], v14 offset:51200
    ds_read_b64_tr_b16 v[58:59], v14 offset:51712
    s_mov_b64 exec, 1
    buffer_store_dwordx2 v[22:23], off, s[36:39], s65 offset:0 sc1
    s_mov_b64 exec, -1
    ds_write_b128 v114, v[120:123] offset:4160
    v_mfma_f32_32x32x16_bf16 v[80:95], v[44:47], v[236:239], v[80:95]
    ds_read_b64_tr_b16 v[60:61], v15 offset:51200
    ds_read_b64_tr_b16 v[62:63], v15 offset:51712
    buffer_load_dwordx4 v5, s[24:27], s53 offen offset:1024 lds
    s_add_u32 s53, s53, 229376
    s_add_u32 m0, s54, 114688
    ds_write_b128 v114, v[124:127] offset:5184
    v_mfma_f32_16x16x32_bf16 a[228:231], a[224:227], v[236:239], a[228:231]
    s_waitcnt lgkmcnt(7)
    v_mfma_f32_32x32x16_bf16 v[64:79], v[48:51], v[240:243], v[64:79]
    ds_read_b64_tr_b16 v[40:41], v16 offset:51200
    ds_read_b64_tr_b16 v[42:43], v16 offset:51712
    buffer_load_dwordx4 v4, s[24:27], s53 offen lds
    ds_write_b128 v114, v[100:103] offset:1056
    v_mov_b32 v115, s57
    v_readlane_b32 s57, v107, 63
    v_alignbyte_b32 v121, v105, v104, 2
    v_mfma_f32_16x16x32_bf16 a[232:235], a[224:227], v[48:51], a[232:235]
    v_mfma_f32_32x32x16_bf16 v[80:95], v[52:55], v[240:243], v[80:95]
    ds_read_b64_tr_b16 v[44:45], v17 offset:51200
    ds_read_b64_tr_b16 v[46:47], v17 offset:51712
    buffer_load_dwordx4 v5, s[24:27], s53 offen offset:1024 lds
    s_add_u32 s53, s53, 229376
    s_add_u32 m0, s54, 116736
    v_mov_b32_dpp v115, v107 wave_shr:1 row_mask:0xf bank_mask:0xf
    v_alignbyte_b32 v122, v106, v105, 2
    v_alignbyte_b32 v123, v107, v106, 2
    v_mfma_f32_16x16x32_bf16 a[236:239], a[224:227], v[52:55], a[236:239]
    v_mfma_f32_16x16x32_bf16 a[228:231], a[224:227], v[240:243], a[228:231]
    s_waitcnt lgkmcnt(6)
    v_mfma_f32_32x32x16_bf16 v[64:79], v[56:59], v[244:247], v[64:79]
    ds_read_b64_tr_b16 v[48:49], v18 offset:51200
    ds_read_b64_tr_b16 v[50:51], v18 offset:51712
    buffer_load_dwordx4 v4, s[24:27], s53 offen lds
    ds_write_b128 v114, v[104:107] offset:2080
    v_alignbyte_b32 v120, v104, v115, 2
    v_mov_b32 v115, s57
    v_readlane_b32 s57, v111, 63
    v_mfma_f32_32x32x16_bf16 v[80:95], v[60:63], v[244:247], v[80:95]
    ds_read_b64_tr_b16 v[52:53], v19 offset:51200
    ds_read_b64_tr_b16 v[54:55], v19 offset:51712
    buffer_load_dwordx4 v5, s[24:27], s53 offen offset:1024 lds
    s_add_u32 m0, s71, 34304
    v_alignbyte_b32 v125, v109, v108, 2
    v_mov_b32_dpp v115, v111 wave_shr:1 row_mask:0xf bank_mask:0xf
    v_alignbyte_b32 v126, v110, v109, 2
    v_mfma_f32_16x16x32_bf16 a[228:231], a[224:227], v[244:247], a[228:231]
    s_waitcnt lgkmcnt(5)
    v_mfma_f32_32x32x16_bf16 v[64:79], v[40:43], v[248:251], v[64:79]
    s_waitcnt vmcnt(16)
    v_add_u32 v12, 0x10000, v12
    ds_read_b64_tr_b16 v[56:57], v12 offset:0
    ds_read_b64_tr_b16 v[58:59], v12 offset:512
    ds_write_b128 v114, v[108:111] offset:3104
    v_alignbyte_b32 v127, v111, v110, 2
    v_alignbyte_b32 v124, v108, v115, 2
    v_mfma_f32_32x32x16_bf16 v[80:95], v[44:47], v[248:251], v[80:95]
    v_add_u32 v13, 0x10000, v13
    ds_read_b64_tr_b16 v[60:61], v13 offset:0
    ds_read_b64_tr_b16 v[62:63], v13 offset:512
    s_waitcnt vmcnt(13)
    v_cmp_ne_u64 vcc, s[42:43], v[24:25]
    s_cbranch_vccnz L_slow_w2
L_back_w2:
    ds_write_b128 v114, v[120:123] offset:6208
    v_mfma_f32_16x16x32_bf16 a[228:231], a[224:227], v[248:251], a[228:231]
    s_waitcnt lgkmcnt(6)
    v_mfma_f32_32x32x16_bf16 v[64:79], v[48:51], v[252:255], v[64:79]
    s_barrier
    v_add_u32 v14, 0x10000, v14
    ds_read_b64_tr_b16 v[40:41], v14 offset:0
    ds_read_b64_tr_b16 v[42:43], v14 offset:512
    buffer_load_dwordx4 a[0:3], v2, s[36:39], s64 offen offset:0 sc1
    v_accvgpr_read_b32 v27, a232
    v_accvgpr_read_b32 v28, a236
    v_mfma_f32_32x32x16_bf16 v[80:95], v[52:55], v[252:255], v[80:95]
    v_add_u32 v15, 0x10000, v15
    ds_read_b64_tr_b16 v[44:45], v15 offset:0
    ds_read_b64_tr_b16 v[46:47], v15 offset:512
    ds_write_b128 v114, v[124:127] offset:7232
    s_lshl_b32 s60, s44, 3
    s_add_u32 s60, s60, 148480
    v_mfma_f32_16x16x32_bf16 a[228:231], a[224:227], v[252:255], a[228:231]
    s_waitcnt lgkmcnt(6)
    v_mfma_f32_32x32x16_bf16 v[96:111], v[56:59], v[128:131], 0
    v_add_u32 v16, 0x10000, v16
    ds_read_b64_tr_b16 v[48:49], v16 offset:0
    ds_read_b64_tr_b16 v[50:51], v16 offset:512
    buffer_load_dwordx4 a[4:7], v2, s[36:39], s64 offen offset:1024 sc1
    v_cmp_gt_u32 vcc, 32, v1
    v_lshlrev_b32 v30, 5, v1
    v_add_u32 v30, s60, v30
    v_cndmask_b32 v27, v28, v27, vcc
    v_and_b32 v28, 0xffff0000, v27
    v_mfma_f32_16x16x32_bf16 a[240:243], a[224:227], v[56:59], 0
    v_mfma_f32_32x32x16_bf16 v[112:127], v[60:63], v[128:131], 0
    v_add_u32 v17, 0x10000, v17
    ds_read_b64_tr_b16 v[52:53], v17 offset:0
    ds_read_b64_tr_b16 v[54:55], v17 offset:512
    buffer_load_dwordx4 a[8:11], v2, s[36:39], s64 offen offset:2048 sc1
    v_sub_f32 v27, v27, v28
    v_and_b32 v29, 0xffff0000, v27
    v_mfma_f32_16x16x32_bf16 a[244:247], a[224:227], v[60:63], 0
    s_waitcnt lgkmcnt(5)
    v_mfma_f32_32x32x16_bf16 v[96:111], v[40:43], v[132:135], v[96:111]
    v_add_u32 v18, 0x10000, v18
    ds_read_b64_tr_b16 v[56:57], v18 offset:0
    ds_read_b64_tr_b16 v[58:59], v18 offset:512
    v_sub_f32 v27, v27, v29
    v_lshrrev_b32 v28, 16, v28
    v_accvgpr_read_b32 v36, a228
    v_mul_f32 v36, 0xbb000000, v36
    v_cvt_pk_bf16_f32 v36, v36, v36
    v_mfma_f32_32x32x16_bf16 v[112:127], v[44:47], v[132:135], v[112:127]
    v_add_u32 v19, 0x10000, v19
    ds_read_b64_tr_b16 v[60:61], v19 offset:0
    ds_read_b64_tr_b16 v[62:63], v19 offset:512
    buffer_load_dwordx4 a[12:15], v2, s[36:39], s64 offen offset:3072 sc1
    s_add_u32 s64, s64, 4096
    v_or_b32 v28, v28, v29
    v_lshrrev_b32 v29, 16, v27
    v_accvgpr_write_b32 a228, v36
    v_accvgpr_write_b32 a229, v36
    v_accvgpr_write_b32 a230, v36
    s_waitcnt lgkmcnt(4)
    v_mfma_f32_32x32x16_bf16 v[96:111], v[48:51], v[136:139], v[96:111]
    ds_read_b64_tr_b16 v[40:41], v12 offset:2048
    ds_read_b64_tr_b16 v[42:43], v12 offset:2560
    buffer_load_dwordx4 a[16:19], v2, s[36:39], s64 offen offset:0 sc1
    ds_write_b64 v30, v[28:29]
    v_accvgpr_write_b32 a231, v36
    v_and_b32 v37, 31, v1
    v_lshrrev_b32 v36, 5, v1
    v_mfma_f32_32x32x16_bf16 v[112:127], v[52:55], v[136:139], v[112:127]
    ds_read_b64_tr_b16 v[44:45], v13 offset:2048
    ds_read_b64_tr_b16 v[46:47], v13 offset:2560
    v_lshlrev_b32 v37, 5, v37
    v_lshl_add_u32 v37, v36, 4, v37
    v_add_u32 v37, 148480, v37
    s_waitcnt lgkmcnt(2)
    v_mfma_f32_32x32x16_bf16 v[96:111], v[56:59], v[140:143], v[96:111]
    s_barrier
    ds_read_b64_tr_b16 v[48:49], v14 offset:2048
    ds_read_b64_tr_b16 v[50:51], v14 offset:2560
    buffer_load_dwordx4 a[20:23], v2, s[36:39], s64 offen offset:1024 sc1
    v_mfma_f32_32x32x16_bf16 v[112:127], v[60:63], v[140:143], v[112:127]
    ds_read_b64_tr_b16 v[52:53], v15 offset:2048
    ds_read_b64_tr_b16 v[54:55], v15 offset:2560
    ds_read_b128 v[28:31], v37 offset:0
    ds_read_b128 v[32:35], v37 offset:1024
    s_waitcnt lgkmcnt(6)
    v_mfma_f32_32x32x16_bf16 v[96:111], v[40:43], v[144:147], v[96:111]
    ds_read_b64_tr_b16 v[56:57], v16 offset:2048
    ds_read_b64_tr_b16 v[58:59], v16 offset:2560
    buffer_load_dwordx4 a[24:27], v2, s[36:39], s64 offen offset:2048 sc1
    v_mfma_f32_16x16x32_bf16 a[240:243], a[224:227], v[40:43], a[240:243]
    v_mfma_f32_32x32x16_bf16 v[112:127], v[44:47], v[144:147], v[112:127]
    ds_read_b64_tr_b16 v[60:61], v17 offset:2048
    ds_read_b64_tr_b16 v[62:63], v17 offset:2560
    buffer_load_dwordx4 a[28:31], v2, s[36:39], s64 offen offset:3072 sc1
    s_add_u32 s64, s64, 4096
    v_mfma_f32_16x16x32_bf16 a[244:247], a[224:227], v[44:47], a[244:247]
    s_waitcnt lgkmcnt(6)
    v_mfma_f32_32x32x16_bf16 v[96:111], v[48:51], v[148:151], v[96:111]
    ds_read_b64_tr_b16 v[40:41], v18 offset:2048
    ds_read_b64_tr_b16 v[42:43], v18 offset:2560
    s_waitcnt lgkmcnt(7)
    v_mfma_f32_32x32x16_bf16 v[64:79], v[28:31], a[228:231], v[64:79]
    v_and_b32 v26, 3, v1
    v_bfe_u32 v38, v1, 2, 1
    v_mfma_f32_32x32x16_bf16 v[112:127], v[52:55], v[148:151], v[112:127]
    ds_read_b64_tr_b16 v[44:45], v19 offset:2048
    ds_read_b64_tr_b16 v[46:47], v19 offset:2560
    buffer_load_dwordx4 a[32:35], v2, s[36:39], s64 offen offset:0 sc1
    s_waitcnt lgkmcnt(8)
    v_mfma_f32_32x32x16_bf16 v[80:95], v[32:35], a[228:231], v[80:95]
    v_lshlrev_b32 v26, 13, v26
    v_lshl_add_u32 v26, v38, 7, v26
    s_waitcnt lgkmcnt(4)
    v_mfma_f32_32x32x16_bf16 v[96:111], v[56:59], v[152:155], v[96:111]
    s_waitcnt vmcnt(20)
    ds_read_b64_tr_b16 v[48:49], v12 offset:16384
    ds_read_b64_tr_b16 v[50:51], v12 offset:16896
    buffer_load_dwordx4 a[36:39], v2, s[36:39], s64 offen offset:1024 sc1
    s_lshr_b32 s40, s46, 2
    s_lshl2_add_u32 s40, s40, s44
    v_mfma_f32_32x32x16_bf16 v[112:127], v[60:63], v[152:155], v[112:127]
    ds_read_b64_tr_b16 v[52:53], v13 offset:16384
    ds_read_b64_tr_b16 v[54:55], v13 offset:16896
    v_cvt_pk_bf16_f32 v64, v64, v65
    v_cvt_pk_bf16_f32 v65, v66, v67
    v_cvt_pk_bf16_f32 v66, v68, v69
    s_lshl_b32 s40, s40, 8
    s_add_u32 s40, s40, 12582912
    s_waitcnt lgkmcnt(4)
    v_mfma_f32_32x32x16_bf16 v[96:111], v[40:43], v[156:159], v[96:111]
    s_barrier
    ds_read_b64_tr_b16 v[56:57], v14 offset:16384
    ds_read_b64_tr_b16 v[58:59], v14 offset:16896
    buffer_load_dwordx2 v[24:25], v26, s[36:39], s40 offen offset:0 sc1
    v_cvt_pk_bf16_f32 v67, v70, v71
    v_pk_max_i16 v64, v64, 0
    v_pk_max_i16 v65, v65, 0
    v_mfma_f32_32x32x16_bf16 v[112:127], v[44:47], v[156:159], v[112:127]
    ds_read_b64_tr_b16 v[60:61], v15 offset:16384
    ds_read_b64_tr_b16 v[62:63], v15 offset:16896
    v_pk_max_i16 v66, v66, 0
    v_pk_max_i16 v67, v67, 0
    s_waitcnt lgkmcnt(4)
    v_mfma_f32_32x32x16_bf16 v[96:111], v[48:51], v[160:163], v[96:111]
    ds_read_b64_tr_b16 v[40:41], v16 offset:16384
    ds_read_b64_tr_b16 v[42:43], v16 offset:16896
    s_add_u32 s3, s55, 0
    buffer_store_dwordx4 v[64:67], v2, s[36:39], s3 offen sc1
    v_mfma_f32_16x16x32_bf16 a[240:243], a[224:227], v[48:51], a[240:243]
    v_mfma_f32_32x32x16_bf16 v[112:127], v[52:55], v[160:163], v[112:127]
    ds_read_b64_tr_b16 v[44:45], v17 offset:16384
    ds_read_b64_tr_b16 v[46:47], v17 offset:16896
    buffer_load_dwordx4 a[40:43], v2, s[36:39], s64 offen offset:2048 sc1
    v_cvt_pk_bf16_f32 v72, v72, v73
    v_cvt_pk_bf16_f32 v73, v74, v75
    v_cvt_pk_bf16_f32 v74, v76, v77
    v_mfma_f32_16x16x32_bf16 a[244:247], a[224:227], v[52:55], a[244:247]
    s_waitcnt lgkmcnt(4)
    v_mfma_f32_32x32x16_bf16 v[96:111], v[56:59], v[164:167], v[96:111]
    ds_read_b64_tr_b16 v[48:49], v18 offset:16384
    ds_read_b64_tr_b16 v[50:51], v18 offset:16896
    v_cvt_pk_bf16_f32 v75, v78, v79
    v_pk_max_i16 v72, v72, 0
    v_pk_max_i16 v73, v73, 0
    v_mfma_f32_32x32x16_bf16 v[112:127], v[60:63], v[164:167], v[112:127]
    ds_read_b64_tr_b16 v[52:53], v19 offset:16384
    ds_read_b64_tr_b16 v[54:55], v19 offset:16896
    buffer_load_dwordx4 a[44:47], v2, s[36:39], s64 offen offset:3072 sc1
    s_add_u32 s64, s64, 4096
    v_pk_max_i16 v74, v74, 0
    v_pk_max_i16 v75, v75, 0
    s_waitcnt lgkmcnt(4)
    v_mfma_f32_32x32x16_bf16 v[96:111], v[40:43], v[168:171], v[96:111]
    s_waitcnt vmcnt(14)
    ds_read_b64_tr_b16 v[56:57], v12 offset:18432
    ds_read_b64_tr_b16 v[58:59], v12 offset:18944
    s_add_u32 s3, s55, 14336
    buffer_store_dwordx4 v[72:75], v2, s[36:39], s3 offen sc1
    v_lshrrev_b32 v27, 4, v1
    v_bfe_u32 v28, v1, 2, 2
    v_mfma_f32_32x32x16_bf16 v[112:127], v[44:47], v[168:171], v[112:127]
    ds_read_b64_tr_b16 v[60:61], v13 offset:18432
    ds_read_b64_tr_b16 v[62:63], v13 offset:18944
    v_and_b32 v29, 3, v1
    v_lshl_add_u32 v29, v27, 2, v29
    s_waitcnt lgkmcnt(4)
    v_mfma_f32_32x32x16_bf16 v[96:111], v[48:51], v[172:175], v[96:111]
    s_barrier
    ds_read_b64_tr_b16 v[40:41], v14 offset:18432
    ds_read_b64_tr_b16 v[42:43], v14 offset:18944
    buffer_load_dwordx4 a[48:51], v2, s[36:39], s64 offen offset:0 sc1
    v_cvt_pk_bf16_f32 v80, v80, v81
    v_cvt_pk_bf16_f32 v81, v82, v83
    v_cvt_pk_bf16_f32 v82, v84, v85
    v_sub_u32 v29, v29, v28
    s_mul_i32 s60, s44, 8256
    v_mfma_f32_32x32x16_bf16 v[112:127], v[52:55], v[172:175], v[112:127]
    ds_read_b64_tr_b16 v[44:45], v15 offset:18432
    ds_read_b64_tr_b16 v[46:47], v15 offset:18944
    buffer_load_dwordx4 a[52:55], v2, s[36:39], s64 offen offset:1024 sc1
    v_cvt_pk_bf16_f32 v83, v86, v87
    v_pk_max_i16 v80, v80, 0
    v_pk_max_i16 v81, v81, 0
    s_add_u32 s60, s60, 24
    v_lshlrev_b32 v29, 3, v29
    s_waitcnt lgkmcnt(4)
    v_mfma_f32_32x32x16_bf16 v[96:111], v[56:59], v[176:179], v[96:111]
    ds_read_b64_tr_b16 v[48:49], v16 offset:18432
    ds_read_b64_tr_b16 v[50:51], v16 offset:18944
    v_pk_max_i16 v82, v82, 0
    v_pk_max_i16 v83, v83, 0
    v_add_u32 v20, s60, v29
    v_and_b32 v28, 15, v1
    v_mfma_f32_16x16x32_bf16 a[240:243], a[224:227], v[56:59], a[240:243]
    v_mfma_f32_32x32x16_bf16 v[112:127], v[60:63], v[176:179], v[112:127]
    ds_read_b64_tr_b16 v[52:53], v17 offset:18432
    ds_read_b64_tr_b16 v[54:55], v17 offset:18944
    s_add_u32 s3, s55, 28672
    buffer_store_dwordx4 v[80:83], v2, s[36:39], s3 offen sc1
    v_sub_u32 v28, v28, v27
    v_add_u32 v28, 16, v28
    v_mfma_f32_16x16x32_bf16 a[244:247], a[224:227], v[60:63], a[244:247]
    s_waitcnt lgkmcnt(4)
    v_mfma_f32_32x32x16_bf16 v[96:111], v[40:43], v[180:183], v[96:111]
    ds_read_b64_tr_b16 v[56:57], v18 offset:18432
    ds_read_b64_tr_b16 v[58:59], v18 offset:18944
    v_lshrrev_b32 v27, 2, v28
    v_and_b32 v28, 3, v28
    v_mfma_f32_32x32x16_bf16 v[112:127], v[44:47], v[180:183], v[112:127]
    ds_read_b64_tr_b16 v[60:61], v19 offset:18432
    ds_read_b64_tr_b16 v[62:63], v19 offset:18944
    buffer_load_dwordx4 a[56:59], v2, s[36:39], s64 offen offset:2048 sc1
    v_cvt_pk_bf16_f32 v88, v88, v89
    v_cvt_pk_bf16_f32 v89, v90, v91
    v_cvt_pk_bf16_f32 v90, v92, v93
    v_lshlrev_b32 v28, 4, v28
    v_lshl_add_u32 v28, v27, 8, v28
    s_waitcnt lgkmcnt(4)
    v_mfma_f32_32x32x16_bf16 v[96:111], v[48:51], v[184:187], v[96:111]
    ds_read_b64_tr_b16 v[40:41], v12 offset:32768
    ds_read_b64_tr_b16 v[42:43], v12 offset:33280
    buffer_load_dwordx4 a[60:63], v2, s[36:39], s64 offen offset:3072 sc1
    s_add_u32 s64, s64, 4096
    v_cvt_pk_bf16_f32 v91, v94, v95
    v_pk_max_i16 v88, v88, 0
    v_pk_max_i16 v89, v89, 0
    v_add_u32 v29, 0, v27
    v_xor_b32 v29, s44, v29
    v_mfma_f32_32x32x16_bf16 v[112:127], v[52:55], v[184:187], v[112:127]
    ds_read_b64_tr_b16 v[44:45], v13 offset:32768
    ds_read_b64_tr_b16 v[46:47], v13 offset:33280
    v_pk_max_i16 v90, v90, 0
    v_pk_max_i16 v91, v91, 0
    v_and_b32 v29, 3, v29
    v_lshl_add_u32 v29, v29, 6, v28
    s_waitcnt lgkmcnt(4)
    v_mfma_f32_32x32x16_bf16 v[96:111], v[56:59], v[188:191], v[96:111]
    ds_read_b64_tr_b16 v[48:49], v14 offset:32768
    ds_read_b64_tr_b16 v[50:51], v14 offset:33280
    s_add_u32 s3, s55, 43008
    buffer_store_dwordx4 v[88:91], v2, s[36:39], s3 offen sc1
    v_add_u32 v8, 33280, v29
    v_add_u32 v29, -1, v27
    v_mfma_f32_32x32x16_bf16 v[112:127], v[60:63], v[188:191], v[112:127]
    ds_read_b64_tr_b16 v[52:53], v15 offset:32768
    ds_read_b64_tr_b16 v[54:55], v15 offset:33280
    buffer_load_dwordx4 a[64:67], v2, s[36:39], s64 offen offset:0 sc1
    v_xor_b32 v29, s44, v29
    v_and_b32 v29, 3, v29
    s_waitcnt lgkmcnt(4)
    v_mfma_f32_32x32x16_bf16 v[96:111], v[40:43], v[192:195], v[96:111]
    ds_read_b64_tr_b16 v[56:57], v16 offset:32768
    ds_read_b64_tr_b16 v[58:59], v16 offset:33280
    v_lshl_add_u32 v29, v29, 6, v28
    v_add_u32 v9, 33024, v29
    v_mfma_f32_16x16x32_bf16 a[240:243], a[224:227], v[40:43], a[240:243]
    v_mfma_f32_32x32x16_bf16 v[112:127], v[44:47], v[192:195], v[112:127]
    ds_read_b64_tr_b16 v[60:61], v17 offset:32768
    ds_read_b64_tr_b16 v[62:63], v17 offset:33280
    buffer_load_dwordx4 a[68:71], v2, s[36:39], s64 offen offset:1024 sc1
    v_add_u32 v29, -2, v27
    v_xor_b32 v29, s44, v29
    v_mfma_f32_16x16x32_bf16 a[244:247], a[224:227], v[44:47], a[244:247]
    s_waitcnt lgkmcnt(4)
    v_mfma_f32_32x32x16_bf16 v[96:111], v[48:51], v[196:199], v[96:111]
    ds_read_b64_tr_b16 v[40:41], v18 offset:32768
    ds_read_b64_tr_b16 v[42:43], v18 offset:33280
    s_waitcnt vmcnt(12)
    v_cmp_ne_u64 vcc, s[42:43], v[24:25]
    s_cbranch_vccnz L_slow_kv
L_back_kv:
    v_and_b32 v29, 3, v29
    v_lshl_add_u32 v29, v29, 6, v28
    v_mfma_f32_32x32x16_bf16 v[112:127], v[52:55], v[196:199], v[112:127]
    ds_read_b64_tr_b16 v[44:45], v19 offset:32768
    ds_read_b64_tr_b16 v[46:47], v19 offset:33280
    v_add_u32 v10, 32768, v29
    v_add_u32 v29, -3, v27
    s_waitcnt lgkmcnt(4)
    v_mfma_f32_32x32x16_bf16 v[96:111], v[56:59], v[200:203], v[96:111]
    s_branch L_over2
L_page2:
    s_branch L_ret
L_over2:
    ds_read_b64_tr_b16 v[48:49], v12 offset:34816
    ds_read_b64_tr_b16 v[50:51], v12 offset:35328
    buffer_load_dwordx4 v2, s[36:39], s69 offen sc1 lds
    v_xor_b32 v29, s44, v29
    v_and_b32 v29, 3, v29
    v_mfma_f32_32x32x16_bf16 v[112:127], v[60:63], v[200:203], v[112:127]
    ds_read_b64_tr_b16 v[52:53], v13 offset:34816
    ds_read_b64_tr_b16 v[54:55], v13 offset:35328
    v_lshl_add_u32 v29, v29, 6, v28
    v_add_u32 v11, 32512, v29
    s_waitcnt lgkmcnt(4)
    v_mfma_f32_32x32x16_bf16 v[96:111], v[40:43], v[204:207], v[96:111]
    ds_read_b64_tr_b16 v[56:57], v14 offset:34816
    ds_read_b64_tr_b16 v[58:59], v14 offset:35328
    buffer_load_dwordx4 a[72:75], v2, s[36:39], s64 offen offset:2048 sc1
    v_mfma_f32_32x32x16_bf16 v[112:127], v[44:47], v[204:207], v[112:127]
    ds_read_b64_tr_b16 v[60:61], v15 offset:34816
    ds_read_b64_tr_b16 v[62:63], v15 offset:35328
    buffer_load_dwordx4 v2, s[36:39], s69 offen offset:1024 sc1 lds
    s_waitcnt lgkmcnt(4)
    v_mfma_f32_32x32x16_bf16 v[96:111], v[48:51], v[208:211], v[96:111]
    ds_read_b64_tr_b16 v[40:41], v16 offset:34816
    ds_read_b64_tr_b16 v[42:43], v16 offset:35328
    v_mfma_f32_16x16x32_bf16 a[240:243], a[224:227], v[48:51], a[240:243]
    v_mfma_f32_32x32x16_bf16 v[112:127], v[52:55], v[208:211], v[112:127]
    ds_read_b64_tr_b16 v[44:45], v17 offset:34816
    ds_read_b64_tr_b16 v[46:47], v17 offset:35328
    buffer_load_dwordx4 a[76:79], v2, s[36:39], s64 offen offset:3072 sc1
    s_add_u32 s64, s64, 4096
    v_mfma_f32_16x16x32_bf16 a[244:247], a[224:227], v[52:55], a[244:247]
    s_waitcnt lgkmcnt(4)
    v_mfma_f32_32x32x16_bf16 v[96:111], v[56:59], v[212:215], v[96:111]
    ds_read_b64_tr_b16 v[48:49], v18 offset:34816
    ds_read_b64_tr_b16 v[50:51], v18 offset:35328
    buffer_load_dwordx4 a[80:83], v2, s[36:39], s64 offen offset:0 sc1
    v_mfma_f32_32x32x16_bf16 v[112:127], v[60:63], v[212:215], v[112:127]
    ds_read_b64_tr_b16 v[52:53], v19 offset:34816
    ds_read_b64_tr_b16 v[54:55], v19 offset:35328
    s_waitcnt lgkmcnt(4)
    v_mfma_f32_32x32x16_bf16 v[96:111], v[40:43], v[216:219], v[96:111]
    ds_read_b64_tr_b16 v[56:57], v12 offset:49152
    ds_read_b64_tr_b16 v[58:59], v12 offset:49664
    buffer_load_dwordx4 a[84:87], v2, s[36:39], s64 offen offset:1024 sc1
    v_mfma_f32_32x32x16_bf16 v[112:127], v[44:47], v[216:219], v[112:127]
    ds_read_b64_tr_b16 v[60:61], v13 offset:49152
    ds_read_b64_tr_b16 v[62:63], v13 offset:49664
    buffer_load_dwordx4 a[88:91], v2, s[36:39], s64 offen offset:2048 sc1
    s_waitcnt lgkmcnt(4)
    v_mfma_f32_32x32x16_bf16 v[96:111], v[48:51], v[220:223], v[96:111]
    ds_read_b64_tr_b16 v[40:41], v14 offset:49152
    ds_read_b64_tr_b16 v[42:43], v14 offset:49664
    v_mfma_f32_32x32x16_bf16 v[112:127], v[52:55], v[220:223], v[112:127]
    ds_read_b64_tr_b16 v[44:45], v15 offset:49152
    ds_read_b64_tr_b16 v[46:47], v15 offset:49664
    buffer_load_dwordx4 a[92:95], v2, s[36:39], s64 offen offset:3072 sc1
    s_add_u32 s64, s64, 4096
    s_waitcnt lgkmcnt(4)
    v_mfma_f32_32x32x16_bf16 v[96:111], v[56:59], v[224:227], v[96:111]
    ds_read_b64_tr_b16 v[48:49], v16 offset:49152
    ds_read_b64_tr_b16 v[50:51], v16 offset:49664
    v_mfma_f32_16x16x32_bf16 a[240:243], a[224:227], v[56:59], a[240:243]
    v_mfma_f32_32x32x16_bf16 v[112:127], v[60:63], v[224:227], v[112:127]
    ds_read_b64_tr_b16 v[52:53], v17 offset:49152
    ds_read_b64_tr_b16 v[54:55], v17 offset:49664
    buffer_load_dwordx4 a[96:99], v2, s[36:39], s64 offen offset:0 sc1
    v_mfma_f32_16x16x32_bf16 a[244:247], a[224:227], v[60:63], a[244:247]
    s_waitcnt lgkmcnt(4)
    v_mfma_f32_32x32x16_bf16 v[96:111], v[40:43], v[228:231], v[96:111]
    ds_read_b64_tr_b16 v[56:57], v18 offset:49152
    ds_read_b64_tr_b16 v[58:59], v18 offset:49664
    buffer_load_dwordx4 a[100:103], v2, s[36:39], s64 offen offset:1024 sc1
    v_mfma_f32_32x32x16_bf16 v[112:127], v[44:47], v[228:231], v[112:127]
    ds_read_b64_tr_b16 v[60:61], v19 offset:49152
    ds_read_b64_tr_b16 v[62:63], v19 offset:49664
    s_waitcnt lgkmcnt(4)
    v_mfma_f32_32x32x16_bf16 v[96:111], v[48:51], v[232:235], v[96:111]
    ds_read_b64_tr_b16 v[40:41], v12 offset:51200
    ds_read_b64_tr_b16 v[42:43], v12 offset:51712
    buffer_load_dwordx4 a[104:107], v2, s[36:39], s64 offen offset:2048 sc1
    v_mfma_f32_32x32x16_bf16 v[112:127], v[52:55], v[232:235], v[112:127]
    ds_read_b64_tr_b16 v[44:45], v13 offset:51200
    ds_read_b64_tr_b16 v[46:47], v13 offset:51712
    s_waitcnt vmcnt(13)
    s_waitcnt vmcnt(8)
    s_waitcnt lgkmcnt(4)
    v_mfma_f32_32x32x16_bf16 v[96:111], v[56:59], v[236:239], v[96:111]
    s_barrier
    ds_read_b64_tr_b16 v[48:49], v14 offset:51200
    ds_read_b64_tr_b16 v[50:51], v14 offset:51712
    buffer_load_dwordx4 a[108:111], v2, s[36:39], s64 offen offset:3072 sc1
    s_add_u32 s64, s64, 4096
    s_mov_b64 exec, 1
    buffer_store_dwordx2 v[22:23], off, s[36:39], s66 offset:0 sc1
    s_mov_b64 exec, -1
    v_mfma_f32_32x32x16_bf16 v[112:127], v[60:63], v[236:239], v[112:127]
    ds_read_b64_tr_b16 v[52:53], v15 offset:51200
    ds_read_b64_tr_b16 v[54:55], v15 offset:51712
    ds_read_b128 v[160:163], v8 offset:0
    ds_read_b64_tr_b16 v[128:129], v20 offset:0
    ds_read_b64_tr_b16 v[130:131], v20 offset:4128
    s_waitcnt lgkmcnt(7)
    v_mfma_f32_32x32x16_bf16 v[96:111], v[40:43], v[240:243], v[96:111]
    ds_read_b64_tr_b16 v[56:57], v16 offset:51200
    ds_read_b64_tr_b16 v[58:59], v16 offset:51712
    buffer_load_dwordx4 a[112:115], v2, s[36:39], s64 offen offset:0 sc1
    ds_read_b128 v[164:167], v8 offset:1024
    ds_read_b64_tr_b16 v[132:133], v20 offset:512
    ds_read_b64_tr_b16 v[134:135], v20 offset:4640
    v_mfma_f32_16x16x32_bf16 a[240:243], a[224:227], v[40:43], a[240:243]
    v_mfma_f32_32x32x16_bf16 v[112:127], v[44:47], v[240:243], v[112:127]
    ds_read_b64_tr_b16 v[60:61], v17 offset:51200
    ds_read_b64_tr_b16 v[62:63], v17 offset:51712
    ds_read_b128 v[168:171], v8 offset:2048
    ds_read_b64_tr_b16 v[136:137], v20 offset:1024
    ds_read_b64_tr_b16 v[138:139], v20 offset:5152
    v_mfma_f32_16x16x32_bf16 a[244:247], a[224:227], v[44:47], a[244:247]
    s_waitcnt lgkmcnt(13)
    v_mfma_f32_32x32x16_bf16 v[96:111], v[48:51], v[244:247], v[96:111]
    ds_read_b64_tr_b16 v[40:41], v18 offset:51200
    ds_read_b64_tr_b16 v[42:43], v18 offset:51712
    buffer_load_dwordx4 a[116:119], v2, s[36:39], s64 offen offset:1024 sc1
    ds_read_b128 v[172:175], v8 offset:3072
    ds_read_b64_tr_b16 v[140:141], v20 offset:1536
    ds_read_b64_tr_b16 v[142:143], v20 offset:5664
    v_accvgpr_read_b32 v27, a240
    v_accvgpr_read_b32 v28, a244
    s_lshl_b32 s60, s44, 3
    s_add_u32 s60, s60, 150528
    v_mfma_f32_32x32x16_bf16 v[112:127], v[52:55], v[244:247], v[112:127]
    ds_read_b64_tr_b16 v[44:45], v19 offset:51200
    ds_read_b64_tr_b16 v[46:47], v19 offset:51712
    ds_read_b128 v[176:179], v8 offset:4096
    ds_read_b64_tr_b16 v[144:145], v20 offset:2048
    ds_read_b64_tr_b16 v[146:147], v20 offset:6176
    v_cmp_gt_u32 vcc, 32, v1
    v_lshlrev_b32 v30, 5, v1
    v_add_u32 v30, s60, v30
    v_cndmask_b32 v27, v28, v27, vcc
    v_and_b32 v28, 0xffff0000, v27
    v_sub_f32 v27, v27, v28
    v_and_b32 v29, 0xffff0000, v27
    s_waitcnt lgkmcnt(13)
    v_mfma_f32_32x32x16_bf16 v[96:111], v[56:59], v[248:251], v[96:111]
    buffer_load_dwordx4 a[120:123], v2, s[36:39], s64 offen offset:2048 sc1
    ds_read_b128 v[180:183], v8 offset:5120
    ds_read_b64_tr_b16 v[148:149], v20 offset:2560
    ds_read_b64_tr_b16 v[150:151], v20 offset:6688
    v_sub_f32 v27, v27, v29
    v_lshrrev_b32 v28, 16, v28
    v_or_b32 v28, v28, v29
    v_lshrrev_b32 v29, 16, v27
    v_mfma_f32_32x32x16_bf16 v[112:127], v[60:63], v[248:251], v[112:127]
    ds_read_b128 v[184:187], v8 offset:6144
    ds_read_b64_tr_b16 v[152:153], v20 offset:3072
    ds_read_b64_tr_b16 v[154:155], v20 offset:7200
    ds_write_b64 v30, v[28:29]
    s_waitcnt lgkmcnt(10)
    v_mfma_f32_32x32x16_bf16 v[96:111], v[40:43], v[252:255], v[96:111]
    buffer_load_dwordx4 a[124:127], v2, s[36:39], s64 offen offset:3072 sc1
    s_add_u32 s64, s64, 4096
    ds_read_b128 v[188:191], v8 offset:7168
    ds_read_b64_tr_b16 v[156:157], v20 offset:3584
    ds_read_b64_tr_b16 v[158:159], v20 offset:7712
    s_waitcnt lgkmcnt(3)
    s_barrier
    ds_read_b128 v[28:31], v37 offset:2048
    ds_read_b128 v[32:35], v37 offset:3072
    v_mfma_f32_32x32x16_bf16 v[112:127], v[44:47], v[252:255], v[112:127]
    s_waitcnt lgkmcnt(1)
    v_mfma_f32_32x32x16_bf16 v[96:111], v[28:31], a[228:231], v[96:111]
    s_waitcnt lgkmcnt(0)
    v_mfma_f32_32x32x16_bf16 v[112:127], v[32:35], a[228:231], v[112:127]
L_conv:
    v_mfma_f32_16x16x32_bf16 a[224:227], v[128:131], v[160:163], 0
    buffer_load_dwordx4 a[128:131], v2, s[36:39], s64 offen offset:0 sc1
    v_mfma_f32_16x16x32_bf16 a[228:231], v[128:131], v[164:167], 0
    v_mfma_f32_16x16x32_bf16 a[228:231], v[132:135], v[160:163], a[228:231]
    ds_read_b128 v[224:227], v9 offset:0
    v_mfma_f32_16x16x32_bf16 a[232:235], v[132:135], v[164:167], 0
    buffer_load_dwordx4 a[132:135], v2, s[36:39], s64 offen offset:1024 sc1
    ds_read_b64_tr_b16 v[192:193], v20 offset:128
    v_mfma_f32_16x16x32_bf16 a[232:235], v[128:131], v[168:171], a[232:235]
    s_nop 0
    v_cvt_pk_bf16_f32 v96, v96, v97
    v_cvt_pk_bf16_f32 v97, v98, v99
    ds_read_b64_tr_b16 v[194:195], v20 offset:4256
    v_mfma_f32_16x16x32_bf16 a[232:235], v[136:139], v[160:163], a[232:235]
    v_cvt_pk_bf16_f32 v98, v100, v101
    v_mfma_f32_16x16x32_bf16 a[236:239], v[132:135], v[168:171], 0
    buffer_load_dwordx4 a[136:139], v2, s[36:39], s64 offen offset:2048 sc1
    v_cvt_pk_bf16_f32 v99, v102, v103
    v_pk_max_i16 v96, v96, 0
    ds_read_b128 v[228:231], v9 offset:1024
    v_mfma_f32_16x16x32_bf16 a[236:239], v[136:139], v[164:167], a[236:239]
    v_pk_max_i16 v97, v97, 0
    ds_read_b64_tr_b16 v[196:197], v20 offset:640
    v_mfma_f32_16x16x32_bf16 a[240:243], v[136:139], v[168:171], 0
    v_pk_max_i16 v98, v98, 0
    v_pk_max_i16 v99, v99, 0
    ds_read_b64_tr_b16 v[198:199], v20 offset:4768
    v_mfma_f32_16x16x32_bf16 a[236:239], v[128:131], v[172:175], a[236:239]
    v_mfma_f32_16x16x32_bf16 a[236:239], v[140:143], v[160:163], a[236:239]
    s_add_u32 s3, s55, 57344
    buffer_store_dwordx4 v[96:99], v2, s[36:39], s3 offen sc1
    ds_read_b128 v[232:235], v9 offset:2048
    v_mfma_f32_16x16x32_bf16 a[240:243], v[132:135], v[172:175], a[240:243]
    ds_read_b64_tr_b16 v[200:201], v20 offset:1152
    v_mfma_f32_16x16x32_bf16 a[240:243], v[140:143], v[164:167], a[240:243]
    ds_read_b64_tr_b16 v[202:203], v20 offset:5280
    v_mfma_f32_16x16x32_bf16 a[244:247], v[136:139], v[172:175], 0
    buffer_load_dwordx4 a[140:143], v2, s[36:39], s64 offen offset:3072 sc1
    s_add_u32 s64, s64, 4096
    v_mfma_f32_16x16x32_bf16 a[244:247], v[140:143], v[168:171], a[244:247]
    v_cvt_pk_bf16_f32 v104, v104, v105
    v_cvt_pk_bf16_f32 v105, v106, v107
    ds_read_b128 v[236:239], v9 offset:3072
    v_mfma_f32_16x16x32_bf16 a[248:251], v[140:143], v[172:175], 0
    v_cvt_pk_bf16_f32 v106, v108, v109
    ds_read_b64_tr_b16 v[204:205], v20 offset:1664
    v_mfma_f32_16x16x32_bf16 a[240:243], v[128:131], v[176:179], a[240:243]
    buffer_load_dwordx4 a[144:147], v2, s[36:39], s64 offen offset:0 sc1
    v_cvt_pk_bf16_f32 v107, v110, v111
    v_pk_max_i16 v104, v104, 0
    ds_read_b64_tr_b16 v[206:207], v20 offset:5792
    v_mfma_f32_16x16x32_bf16 a[240:243], v[144:147], v[160:163], a[240:243]
    v_pk_max_i16 v105, v105, 0
    v_mfma_f32_16x16x32_bf16 a[244:247], v[132:135], v[176:179], a[244:247]
    v_pk_max_i16 v106, v106, 0
    v_pk_max_i16 v107, v107, 0
    ds_read_b128 v[240:243], v9 offset:4096
    v_mfma_f32_16x16x32_bf16 a[244:247], v[144:147], v[164:167], a[244:247]
    ds_read_b64_tr_b16 v[208:209], v20 offset:2176
    v_mfma_f32_16x16x32_bf16 a[248:251], v[136:139], v[176:179], a[248:251]
    s_add_u32 s3, s55, 71680
    buffer_store_dwordx4 v[104:107], v2, s[36:39], s3 offen sc1
    ds_read_b64_tr_b16 v[210:211], v20 offset:6304
    v_mfma_f32_16x16x32_bf16 a[248:251], v[144:147], v[168:171], a[248:251]
    v_mfma_f32_16x16x32_bf16 a[252:255], v[140:143], v[176:179], 0
    ds_read_b128 v[244:247], v9 offset:5120
    v_mfma_f32_16x16x32_bf16 a[252:255], v[144:147], v[172:175], a[252:255]
    buffer_load_dwordx4 a[148:151], v2, s[36:39], s64 offen offset:1024 sc1
    ds_read_b64_tr_b16 v[212:213], v20 offset:2688
    v_mfma_f32_16x16x32_bf16 a[244:247], v[128:131], v[180:183], a[244:247]
    v_cvt_pk_bf16_f32 v112, v112, v113
    v_cvt_pk_bf16_f32 v113, v114, v115
    ds_read_b64_tr_b16 v[214:215], v20 offset:6816
    v_mfma_f32_16x16x32_bf16 a[244:247], v[148:151], v[160:163], a[244:247]
    v_cvt_pk_bf16_f32 v114, v116, v117
    v_mfma_f32_16x16x32_bf16 a[248:251], v[132:135], v[180:183], a[248:251]
    buffer_load_dwordx4 a[152:155], v2, s[36:39], s64 offen offset:2048 sc1
    v_cvt_pk_bf16_f32 v115, v118, v119
    v_pk_max_i16 v112, v112, 0
    ds_read_b128 v[248:251], v9 offset:6144
    v_mfma_f32_16x16x32_bf16 a[248:251], v[148:151], v[164:167], a[248:251]
    v_pk_max_i16 v113, v113, 0
    ds_read_b64_tr_b16 v[216:217], v20 offset:3200
    v_mfma_f32_16x16x32_bf16 a[252:255], v[136:139], v[180:183], a[252:255]
    v_pk_max_i16 v114, v114, 0
    v_pk_max_i16 v115, v115, 0
    ds_read_b64_tr_b16 v[218:219], v20 offset:7328
    v_mfma_f32_16x16x32_bf16 a[252:255], v[148:151], v[168:171], a[252:255]
    v_mfma_f32_16x16x32_bf16 a[248:251], v[128:131], v[184:187], a[248:251]
    s_add_u32 s3, s55, 86016
    buffer_store_dwordx4 v[112:115], v2, s[36:39], s3 offen sc1
    ds_read_b128 v[252:255], v9 offset:7168
    v_mfma_f32_16x16x32_bf16 a[248:251], v[152:155], v[160:163], a[248:251]
    ds_read_b64_tr_b16 v[220:221], v20 offset:3712
    v_mfma_f32_16x16x32_bf16 a[252:255], v[132:135], v[184:187], a[252:255]
    ds_read_b64_tr_b16 v[222:223], v20 offset:7840
    v_mfma_f32_16x16x32_bf16 a[252:255], v[152:155], v[164:167], a[252:255]
    buffer_load_dwordx4 a[156:159], v2, s[36:39], s64 offen offset:3072 sc1
    s_add_u32 s64, s64, 4096
    v_mfma_f32_16x16x32_bf16 a[252:255], v[128:131], v[188:191], a[252:255]
    v_cvt_pk_bf16_f32 v120, v120, v121
    v_cvt_pk_bf16_f32 v121, v122, v123
    v_mfma_f32_16x16x32_bf16 a[252:255], v[156:159], v[160:163], a[252:255]
    v_cvt_pk_bf16_f32 v122, v124, v125
    s_waitcnt lgkmcnt(15)
    v_mfma_f32_16x16x32_bf16 a[224:227], v[192:195], v[224:227], a[224:227]
    buffer_load_dwordx4 a[160:163], v2, s[36:39], s64 offen offset:0 sc1
    v_cvt_pk_bf16_f32 v123, v126, v127
    v_pk_max_i16 v120, v120, 0
    v_mfma_f32_16x16x32_bf16 a[228:231], v[192:195], v[228:231], a[228:231]
    v_pk_max_i16 v121, v121, 0
    v_mfma_f32_16x16x32_bf16 a[228:231], v[196:199], v[224:227], a[228:231]
    v_pk_max_i16 v122, v122, 0
    v_pk_max_i16 v123, v123, 0
    ds_read_b128 v[160:163], v10 offset:0
    v_mfma_f32_16x16x32_bf16 a[232:235], v[196:199], v[228:231], a[232:235]
    ds_read_b64_tr_b16 v[128:129], v20 offset:256
    v_mfma_f32_16x16x32_bf16 a[232:235], v[192:195], v[232:235], a[232:235]
    s_add_u32 s3, s55, 100352
    buffer_store_dwordx4 v[120:123], v2, s[36:39], s3 offen sc1
    ds_read_b64_tr_b16 v[130:131], v20 offset:4384
    v_mfma_f32_16x16x32_bf16 a[232:235], v[200:203], v[224:227], a[232:235]
    v_min_u32 v26, 13, v1
    v_mfma_f32_16x16x32_bf16 a[236:239], v[196:199], v[232:235], a[236:239]
    v_lshlrev_b32 v26, 8, v26
    ds_read_b128 v[164:167], v10 offset:1024
    v_mfma_f32_16x16x32_bf16 a[236:239], v[200:203], v[228:231], a[236:239]
    buffer_load_dwordx4 a[164:167], v2, s[36:39], s64 offen offset:1024 sc1
    s_lshr_b32 s40, s47, 1
    ds_read_b64_tr_b16 v[132:133], v20 offset:768
    v_mfma_f32_16x16x32_bf16 a[240:243], v[200:203], v[232:235], a[240:243]
    s_mul_i32 s40, s40, 3584
    ds_read_b64_tr_b16 v[134:135], v20 offset:4896
    s_waitcnt lgkmcnt(15)
    v_mfma_f32_16x16x32_bf16 a[236:239], v[192:195], v[236:239], a[236:239]
    s_add_u32 s40, s40, 12845056
    v_mfma_f32_16x16x32_bf16 a[236:239], v[204:207], v[224:227], a[236:239]
    buffer_load_dwordx4 a[168:171], v2, s[36:39], s64 offen offset:2048 sc1
    s_mul_i32 s68, s47, 224
    ds_read_b128 v[168:171], v10 offset:2048
    v_mfma_f32_16x16x32_bf16 a[240:243], v[196:199], v[236:239], a[240:243]
    s_mul_i32 s60, s44, 14
    ds_read_b64_tr_b16 v[136:137], v20 offset:1280
    v_mfma_f32_16x16x32_bf16 a[240:243], v[204:207], v[228:231], a[240:243]
    s_add_u32 s68, s68, s60
    ds_read_b64_tr_b16 v[138:139], v20 offset:5408
    v_mfma_f32_16x16x32_bf16 a[244:247], v[200:203], v[236:239], a[244:247]
    s_lshl_b32 s68, s68, 10
    v_mfma_f32_16x16x32_bf16 a[244:247], v[204:207], v[232:235], a[244:247]
    buffer_load_dwordx4 a[172:175], v2, s[36:39], s64 offen offset:3072 sc1
    s_add_u32 s64, s64, 4096
    s_add_u32 s68, s68, 4194304
    ds_read_b128 v[172:175], v10 offset:3072
    v_mfma_f32_16x16x32_bf16 a[248:251], v[204:207], v[236:239], a[248:251]
    s_lshr_b32 s60, s44, 1
    s_mul_i32 s60, s60, 114688
    v_add_u32 v14, s60, v2
    s_sub_u32 s60, 114688, s60
    v_add_u32 v21, s60, v2
    ds_read_b64_tr_b16 v[140:141], v20 offset:1792
    v_mfma_f32_16x16x32_bf16 a[240:243], v[192:195], v[240:243], a[240:243]
    ds_read_b64_tr_b16 v[142:143], v20 offset:5920
    v_mfma_f32_16x16x32_bf16 a[240:243], v[208:211], v[224:227], a[240:243]
    buffer_load_dwordx2 v[24:25], v26, s[36:39], s40 offen offset:0 sc1
    v_mfma_f32_16x16x32_bf16 a[244:247], v[196:199], v[240:243], a[244:247]
    v_lshrrev_b32 v27, 4, v1
    ds_read_b128 v[176:179], v10 offset:4096
    v_mfma_f32_16x16x32_bf16 a[244:247], v[208:211], v[228:231], a[244:247]
    v_and_b32 v28, 15, v1
    ds_read_b64_tr_b16 v[144:145], v20 offset:2304
    v_mfma_f32_16x16x32_bf16 a[248:251], v[200:203], v[240:243], a[248:251]
    v_mul_u32_u24 v27, 20, v27
    ds_read_b64_tr_b16 v[146:147], v20 offset:6432
    v_mfma_f32_16x16x32_bf16 a[248:251], v[208:211], v[232:235], a[248:251]
    buffer_load_dwordx4 a[176:179], v2, s[36:39], s64 offen offset:0 sc1
    v_add_lshl_u32 v27, v27, v28, 4
    v_mfma_f32_16x16x32_bf16 a[252:255], v[204:207], v[240:243], a[252:255]
    s_mul_i32 s60, s44, 10240
    ds_read_b128 v[180:183], v10 offset:5120
    v_mfma_f32_16x16x32_bf16 a[252:255], v[208:211], v[236:239], a[252:255]
    s_add_u32 s60, s60, 90112
    ds_read_b64_tr_b16 v[148:149], v20 offset:2816
    s_waitcnt lgkmcnt(15)
    v_mfma_f32_16x16x32_bf16 a[244:247], v[192:195], v[244:247], a[244:247]
    buffer_load_dwordx4 a[180:183], v2, s[36:39], s64 offen offset:1024 sc1
    v_add_u32 v12, s60, v27
    ds_read_b64_tr_b16 v[150:151], v20 offset:6944
    v_mfma_f32_16x16x32_bf16 a[244:247], v[212:215], v[224:227], a[244:247]
    v_and_b32 v28, 3, v1
    v_mfma_f32_16x16x32_bf16 a[248:251], v[196:199], v[244:247], a[248:251]
    v_lshrrev_b32 v29, 2, v1
    ds_read_b128 v[184:187], v10 offset:6144
    v_mfma_f32_16x16x32_bf16 a[248:251], v[212:215], v[228:231], a[248:251]
    v_mul_u32_u24 v28, 20, v28
    ds_read_b64_tr_b16 v[152:153], v20 offset:3328
    v_mfma_f32_16x16x32_bf16 a[252:255], v[200:203], v[244:247], a[252:255]
    buffer_load_dwordx4 a[184:187], v2, s[36:39], s64 offen offset:2048 sc1
    v_add_lshl_u32 v28, v28, v29, 4
    ds_read_b64_tr_b16 v[154:155], v20 offset:7456
    v_mfma_f32_16x16x32_bf16 a[252:255], v[212:215], v[232:235], a[252:255]
    s_mul_i32 s60, s44, 2560
    v_mfma_f32_16x16x32_bf16 a[248:251], v[192:195], v[248:251], a[248:251]
    s_add_u32 s60, s60, 90112
    ds_read_b128 v[188:191], v10 offset:7168
    v_mfma_f32_16x16x32_bf16 a[248:251], v[216:219], v[224:227], a[248:251]
    buffer_load_dwordx4 a[188:191], v2, s[36:39], s64 offen offset:3072 sc1
    s_add_u32 s64, s64, 4096
    v_add_u32 v13, s60, v28
    ds_read_b64_tr_b16 v[156:157], v20 offset:3840
    v_mfma_f32_16x16x32_bf16 a[252:255], v[196:199], v[248:251], a[252:255]
    ds_read_b64_tr_b16 v[158:159], v20 offset:7968
    v_mfma_f32_16x16x32_bf16 a[252:255], v[216:219], v[228:231], a[252:255]
    v_mfma_f32_16x16x32_bf16 a[252:255], v[192:195], v[252:255], a[252:255]
    v_mfma_f32_16x16x32_bf16 a[252:255], v[220:223], v[224:227], a[252:255]
    s_waitcnt vmcnt(8)
    s_barrier
    s_mov_b64 exec, 1
    buffer_store_dwordx2 v[22:23], off, s[36:39], s66 offset:128 sc1
    s_mov_b64 exec, -1
    s_waitcnt lgkmcnt(15)
    v_mfma_f32_16x16x32_bf16 a[224:227], v[128:131], v[160:163], a[224:227]
    v_mfma_f32_16x16x32_bf16 a[228:231], v[128:131], v[164:167], a[228:231]
    v_mfma_f32_16x16x32_bf16 a[228:231], v[132:135], v[160:163], a[228:231]
    buffer_load_dwordx4 a[192:195], v2, s[36:39], s64 offen offset:0 sc1
    ds_read_b128 v[224:227], v11 offset:0
    v_mfma_f32_16x16x32_bf16 a[232:235], v[132:135], v[164:167], a[232:235]
    ds_read_b64_tr_b16 v[192:193], v20 offset:384
    v_mfma_f32_16x16x32_bf16 a[232:235], v[128:131], v[168:171], a[232:235]
    ds_read_b64_tr_b16 v[194:195], v20 offset:4512
    v_mfma_f32_16x16x32_bf16 a[232:235], v[136:139], v[160:163], a[232:235]
    v_mfma_f32_16x16x32_bf16 a[236:239], v[132:135], v[168:171], a[236:239]
    buffer_load_dwordx4 a[196:199], v2, s[36:39], s64 offen offset:1024 sc1
    ds_read_b128 v[228:231], v11 offset:1024
    v_mfma_f32_16x16x32_bf16 a[236:239], v[136:139], v[164:167], a[236:239]
    ds_read_b64_tr_b16 v[196:197], v20 offset:896
    v_mfma_f32_16x16x32_bf16 a[240:243], v[136:139], v[168:171], a[240:243]
    ds_read_b64_tr_b16 v[198:199], v20 offset:5024
    s_waitcnt lgkmcnt(15)
    v_mfma_f32_16x16x32_bf16 a[236:239], v[128:131], v[172:175], a[236:239]
    buffer_load_dwordx4 a[200:203], v2, s[36:39], s64 offen offset:2048 sc1
    v_mfma_f32_16x16x32_bf16 a[236:239], v[140:143], v[160:163], a[236:239]
    ds_read_b128 v[232:235], v11 offset:2048
    v_mfma_f32_16x16x32_bf16 a[240:243], v[132:135], v[172:175], a[240:243]
    ds_read_b64_tr_b16 v[200:201], v20 offset:1408
    v_mfma_f32_16x16x32_bf16 a[240:243], v[140:143], v[164:167], a[240:243]
    ds_read_b64_tr_b16 v[202:203], v20 offset:5536
    v_mfma_f32_16x16x32_bf16 a[244:247], v[136:139], v[172:175], a[244:247]
    buffer_load_dwordx4 a[204:207], v2, s[36:39], s64 offen offset:3072 sc1
    s_add_u32 s64, s64, 4096
    v_mfma_f32_16x16x32_bf16 a[244:247], v[140:143], v[168:171], a[244:247]
    ds_read_b128 v[236:239], v11 offset:3072
    v_mfma_f32_16x16x32_bf16 a[248:251], v[140:143], v[172:175], a[248:251]
    v_and_b32 v19, 0x30, v1
    ds_read_b64_tr_b16 v[204:205], v20 offset:1920
    v_mfma_f32_16x16x32_bf16 a[240:243], v[128:131], v[176:179], a[240:243]
    s_and_b32 s3, s44, 1
    s_lshl_b32 s3, s3, 6
    v_xor_b32 v19, s3, v19
    ds_read_b64_tr_b16 v[206:207], v20 offset:6048
    v_mfma_f32_16x16x32_bf16 a[240:243], v[144:147], v[160:163], a[240:243]
    s_waitcnt vmcnt(9)
    v_cmp_ne_u64 vcc, s[42:43], v[24:25]
    s_cbranch_vccnz L_slow_h0
L_back_h0:
    v_xor_b32 v19, v3, v19
    v_mfma_f32_16x16x32_bf16 a[244:247], v[132:135], v[176:179], a[244:247]
    s_add_u32 m0, s71, 140288
    ds_read_b128 v[240:243], v11 offset:4096
    v_mfma_f32_16x16x32_bf16 a[244:247], v[144:147], v[164:167], a[244:247]
    buffer_load_dwordx4 v19, s[4:7], s70 offen lds
    ds_read_b64_tr_b16 v[208:209], v20 offset:2432
    v_mfma_f32_16x16x32_bf16 a[248:251], v[136:139], v[176:179], a[248:251]
    ds_read_b64_tr_b16 v[210:211], v20 offset:6560
    v_mfma_f32_16x16x32_bf16 a[248:251], v[144:147], v[168:171], a[248:251]
    v_mfma_f32_16x16x32_bf16 a[252:255], v[140:143], v[176:179], a[252:255]
    s_add_u32 s3, s70, 7168
    buffer_load_dwordx4 v19, s[4:7], s3 offen offset:1024 lds
    ds_read_b128 v[244:247], v11 offset:5120
    v_mfma_f32_16x16x32_bf16 a[252:255], v[144:147], v[172:175], a[252:255]
    ds_read_b64_tr_b16 v[212:213], v20 offset:2944
    s_waitcnt lgkmcnt(15)
    v_mfma_f32_16x16x32_bf16 a[244:247], v[128:131], v[180:183], a[244:247]
    ds_read_b64_tr_b16 v[214:215], v20 offset:7072
    v_mfma_f32_16x16x32_bf16 a[244:247], v[148:151], v[160:163], a[244:247]
    buffer_load_dwordx4 v[40:43], v14, s[36:39], s68 offen offset:0 sc1
    v_mfma_f32_16x16x32_bf16 a[248:251], v[132:135], v[180:183], a[248:251]
    ds_read_b128 v[248:251], v11 offset:6144
    v_mfma_f32_16x16x32_bf16 a[248:251], v[148:151], v[164:167], a[248:251]
    ds_read_b64_tr_b16 v[216:217], v20 offset:3456
    v_mfma_f32_16x16x32_bf16 a[252:255], v[136:139], v[180:183], a[252:255]
    buffer_load_dwordx4 a[208:211], v2, s[36:39], s64 offen offset:0 sc1
    ds_read_b64_tr_b16 v[218:219], v20 offset:7584
    v_mfma_f32_16x16x32_bf16 a[252:255], v[148:151], v[168:171], a[252:255]
    v_mfma_f32_16x16x32_bf16 a[248:251], v[128:131], v[184:187], a[248:251]
    buffer_load_dwordx4 v[44:47], v21, s[36:39], s68 offen offset:0 sc1
    ds_read_b128 v[252:255], v11 offset:7168
    v_mfma_f32_16x16x32_bf16 a[248:251], v[152:155], v[160:163], a[248:251]
    ds_read_b64_tr_b16 v[220:221], v20 offset:3968
    v_mfma_f32_16x16x32_bf16 a[252:255], v[132:135], v[184:187], a[252:255]
    ds_read_b64_tr_b16 v[222:223], v20 offset:8096
    v_mfma_f32_16x16x32_bf16 a[252:255], v[152:155], v[164:167], a[252:255]
    buffer_load_dwordx4 v[48:51], v14, s[36:39], s68 offen offset:1024 sc1
    v_mfma_f32_16x16x32_bf16 a[252:255], v[128:131], v[188:191], a[252:255]
    v_mfma_f32_16x16x32_bf16 a[252:255], v[156:159], v[160:163], a[252:255]
    s_waitcnt lgkmcnt(11)
    v_mfma_f32_16x16x32_bf16 a[252:255], v[204:207], v[240:243], a[252:255]
    buffer_load_dwordx4 v[52:55], v21, s[36:39], s68 offen offset:1024 sc1
    s_waitcnt lgkmcnt(9)
    v_mfma_f32_16x16x32_bf16 a[252:255], v[208:211], v[236:239], a[252:255]
    s_waitcnt lgkmcnt(8)
    v_mfma_f32_16x16x32_bf16 a[252:255], v[200:203], v[244:247], a[252:255]
    s_waitcnt lgkmcnt(6)
    v_mfma_f32_16x16x32_bf16 a[252:255], v[212:215], v[232:235], a[252:255]
    buffer_load_dwordx4 a[212:215], v2, s[36:39], s64 offen offset:1024 sc1
    s_waitcnt lgkmcnt(5)
    v_mfma_f32_16x16x32_bf16 a[252:255], v[196:199], v[248:251], a[252:255]
    s_waitcnt lgkmcnt(3)
    v_mfma_f32_16x16x32_bf16 a[252:255], v[216:219], v[228:231], a[252:255]
    buffer_load_dwordx4 v[56:59], v14, s[36:39], s68 offen offset:2048 sc1
    s_waitcnt lgkmcnt(2)
    v_mfma_f32_16x16x32_bf16 a[252:255], v[192:195], v[252:255], a[252:255]
    s_waitcnt lgkmcnt(0)
    v_mfma_f32_16x16x32_bf16 a[252:255], v[220:223], v[224:227], a[252:255]
    v_mfma_f32_16x16x32_bf16 a[248:251], v[204:207], v[236:239], a[248:251]
    buffer_load_dwordx4 v[60:63], v21, s[36:39], s68 offen offset:2048 sc1
    v_mfma_f32_16x16x32_bf16 a[248:251], v[200:203], v[240:243], a[248:251]
    s_nop 4
    ds_write_b128 v12, a[252:255] offset:8960
    v_mfma_f32_16x16x32_bf16 a[248:251], v[208:211], v[232:235], a[248:251]
    v_mfma_f32_16x16x32_bf16 a[248:251], v[196:199], v[244:247], a[248:251]
    buffer_load_dwordx4 v[64:67], v14, s[36:39], s68 offen offset:3072 sc1
    v_mfma_f32_16x16x32_bf16 a[248:251], v[212:215], v[228:231], a[248:251]
    v_mfma_f32_16x16x32_bf16 a[248:251], v[192:195], v[248:251], a[248:251]
    v_mfma_f32_16x16x32_bf16 a[248:251], v[216:219], v[224:227], a[248:251]
    buffer_load_dwordx4 a[216:219], v2, s[36:39], s64 offen offset:2048 sc1
    v_mfma_f32_16x16x32_bf16 a[244:247], v[200:203], v[236:239], a[244:247]
    v_mfma_f32_16x16x32_bf16 a[244:247], v[204:207], v[232:235], a[244:247]
    buffer_load_dwordx4 v[68:71], v21, s[36:39], s68 offen offset:3072 sc1
    s_nop 3
    ds_write_b128 v12, a[248:251] offset:7680
    v_mfma_f32_16x16x32_bf16 a[244:247], v[196:199], v[240:243], a[244:247]
    v_mfma_f32_16x16x32_bf16 a[244:247], v[208:211], v[228:231], a[244:247]
    v_mfma_f32_16x16x32_bf16 a[244:247], v[192:195], v[244:247], a[244:247]
    s_add_u32 s68, s68, 4096
    buffer_load_dwordx4 v[72:75], v14, s[36:39], s68 offen offset:0 sc1
    v_mfma_f32_16x16x32_bf16 a[244:247], v[212:215], v[224:227], a[244:247]
    v_mfma_f32_16x16x32_bf16 a[240:243], v[200:203], v[232:235], a[240:243]
    v_mfma_f32_16x16x32_bf16 a[240:243], v[196:199], v[236:239], a[240:243]
    buffer_load_dwordx4 v[76:79], v21, s[36:39], s68 offen offset:0 sc1
    s_nop 4
    ds_write_b128 v12, a[244:247] offset:6400
    v_mfma_f32_16x16x32_bf16 a[240:243], v[204:207], v[228:231], a[240:243]
    v_mfma_f32_16x16x32_bf16 a[240:243], v[192:195], v[240:243], a[240:243]
    v_mfma_f32_16x16x32_bf16 a[240:243], v[208:211], v[224:227], a[240:243]
    buffer_load_dwordx4 a[220:223], v2, s[36:39], s64 offen offset:3072 sc1
    v_mfma_f32_16x16x32_bf16 a[236:239], v[196:199], v[232:235], a[236:239]
    v_mfma_f32_16x16x32_bf16 a[236:239], v[200:203], v[228:231], a[236:239]
    buffer_load_dwordx4 v[80:83], v14, s[36:39], s68 offen offset:1024 sc1
    s_nop 3
    ds_write_b128 v12, a[240:243] offset:5120
    v_mfma_f32_16x16x32_bf16 a[236:239], v[192:195], v[236:239], a[236:239]
    v_mfma_f32_16x16x32_bf16 a[236:239], v[204:207], v[224:227], a[236:239]
    v_mfma_f32_16x16x32_bf16 a[232:235], v[196:199], v[228:231], a[232:235]
    buffer_load_dwordx4 v[84:87], v21, s[36:39], s68 offen offset:1024 sc1
    v_mfma_f32_16x16x32_bf16 a[232:235], v[192:195], v[232:235], a[232:235]
    s_nop 4
    ds_write_b128 v12, a[236:239] offset:3840
    v_mfma_f32_16x16x32_bf16 a[232:235], v[200:203], v[224:227], a[232:235]
    v_mfma_f32_16x16x32_bf16 a[228:231], v[192:195], v[228:231], a[228:231]
    buffer_load_dwordx4 v[88:91], v14, s[36:39], s68 offen offset:2048 sc1
    v_mfma_f32_16x16x32_bf16 a[228:231], v[196:199], v[224:227], a[228:231]
    s_nop 4
    ds_write_b128 v12, a[232:235] offset:2560
    v_mfma_f32_16x16x32_bf16 a[224:227], v[192:195], v[224:227], a[224:227]
    s_waitcnt vmcnt(16)
    v_mfma_f32_32x32x16_bf16 v[192:207], a[0:3], v[40:43], 0
    buffer_load_dwordx4 v[92:95], v21, s[36:39], s68 offen offset:2048 sc1
    ds_write_b128 v12, a[228:231] offset:1280
    s_nop 3
    ds_write_b128 v12, a[224:227] offset:0
    v_add_u32 v27, s71, v2
    v_mfma_f32_32x32x16_bf16 v[208:223], a[4:7], v[40:43], 0
    buffer_load_dwordx4 v[96:99], v14, s[36:39], s68 offen offset:3072 sc1
    ds_read_b128 v[28:31], v27 offset:34304
    s_waitcnt vmcnt(16)
    v_mfma_f32_32x32x16_bf16 v[224:239], a[0:3], v[44:47], 0
    s_branch L_over3
L_page3:
    s_branch L_ret
L_page32:
    s_branch L_ret2
L_over3:
    s_waitcnt lgkmcnt(1)
    s_barrier
    ds_read_b128 v[160:163], v13 offset:0
    ds_read_b128 v[32:35], v27 offset:35328
    v_mfma_f32_32x32x16_bf16 v[240:255], a[4:7], v[44:47], 0
    buffer_load_dwordx4 v[100:103], v21, s[36:39], s68 offen offset:3072 sc1
    ds_read_b128 v[164:167], v13 offset:10240
    ds_read_b128 v[168:171], v13 offset:20480
    s_waitcnt vmcnt(16)
    v_mfma_f32_32x32x16_bf16 v[192:207], a[8:11], v[48:51], v[192:207]
    ds_read_b128 v[172:175], v13 offset:30720
    ds_read_b128 v[176:179], v13 offset:1280
    v_mfma_f32_32x32x16_bf16 v[208:223], a[12:15], v[48:51], v[208:223]
    s_add_u32 s68, s68, 4096
    buffer_load_dwordx4 v[104:107], v14, s[36:39], s68 offen offset:0 sc1
    ds_read_b128 v[180:183], v13 offset:11520
    ds_read_b128 v[184:187], v13 offset:21760
    s_waitcnt vmcnt(16)
    v_mfma_f32_32x32x16_bf16 v[224:239], a[8:11], v[52:55], v[224:239]
    ds_read_b128 v[188:191], v13 offset:32000
    v_mfma_f32_32x32x16_bf16 v[240:255], a[12:15], v[52:55], v[240:255]
    buffer_load_dwordx2 v[24:25], v26, s[36:39], s40 offen offset:128 sc1
    s_waitcnt lgkmcnt(6)
    v_add_f32 v160, v160, v164
    v_add_f32 v161, v161, v165
    v_add_f32 v162, v162, v166
    v_add_f32 v163, v163, v167
    s_waitcnt lgkmcnt(4)
    v_add_f32 v168, v168, v172
    s_waitcnt vmcnt(15)
    v_mfma_f32_32x32x16_bf16 v[192:207], a[16:19], v[56:59], v[192:207]
    v_add_f32 v169, v169, v173
    v_add_f32 v170, v170, v174
    v_add_f32 v171, v171, v175
    v_cvt_pk_bf16_f32 v164, v160, v168
    v_cvt_pk_bf16_f32 v165, v161, v169
    v_mfma_f32_32x32x16_bf16 v[208:223], a[20:23], v[56:59], v[208:223]
    buffer_load_dwordx4 v[108:111], v21, s[36:39], s68 offen offset:0 sc1
    v_cvt_pk_bf16_f32 v166, v162, v170
    v_cvt_pk_bf16_f32 v167, v163, v171
    v_min_u32 v164, -2, v164
    v_min_u32 v165, -2, v165
    v_min_u32 v166, -2, v166
    s_waitcnt vmcnt(15)
    v_mfma_f32_32x32x16_bf16 v[224:239], a[16:19], v[60:63], v[224:239]
    v_min_u32 v167, -2, v167
    v_add3_u32 v164, v164, v28, 1
    v_add3_u32 v165, v165, v29, 1
    v_add3_u32 v166, v166, v30, 1
    v_add3_u32 v167, v167, v31, 1
    v_mfma_f32_32x32x16_bf16 v[240:255], a[20:23], v[60:63], v[240:255]
    buffer_store_dwordx4 v[164:167], v2, s[36:39], s69 offen offset:0 sc1
    s_waitcnt lgkmcnt(2)
    v_add_f32 v176, v176, v180
    v_add_f32 v177, v177, v181
    v_add_f32 v178, v178, v182
    v_add_f32 v179, v179, v183
    s_waitcnt lgkmcnt(0)
    v_add_f32 v184, v184, v188
    s_waitcnt vmcnt(15)
    v_mfma_f32_32x32x16_bf16 v[192:207], a[24:27], v[64:67], v[192:207]
    v_add_f32 v185, v185, v189
    v_add_f32 v186, v186, v190
    v_add_f32 v187, v187, v191
    v_cvt_pk_bf16_f32 v180, v176, v184
    v_cvt_pk_bf16_f32 v181, v177, v185
    v_mfma_f32_32x32x16_bf16 v[208:223], a[28:31], v[64:67], v[208:223]
    buffer_load_dwordx4 v[112:115], v14, s[36:39], s68 offen offset:1024 sc1
    v_cvt_pk_bf16_f32 v182, v178, v186
    v_cvt_pk_bf16_f32 v183, v179, v187
    v_min_u32 v180, -2, v180
    v_min_u32 v181, -2, v181
    v_min_u32 v182, -2, v182
    s_waitcnt vmcnt(14)
    v_mfma_f32_32x32x16_bf16 v[224:239], a[24:27], v[68:71], v[224:239]
    v_min_u32 v183, -2, v183
    v_add3_u32 v180, v180, v32, 1
    v_add3_u32 v181, v181, v33, 1
    v_add3_u32 v182, v182, v34, 1
    v_add3_u32 v183, v183, v35, 1
    v_mfma_f32_32x32x16_bf16 v[240:255], a[28:31], v[68:71], v[240:255]
    buffer_store_dwordx4 v[180:183], v2, s[36:39], s69 offen offset:1024 sc1
    s_waitcnt vmcnt(14)
    v_mfma_f32_32x32x16_bf16 v[192:207], a[32:35], v[72:75], v[192:207]
    v_add_u32 v15, s54, v2
    v_xor_b32 v16, 0x3000, v15
    v_xor_b32 v17, 0x2000, v15
    v_mfma_f32_32x32x16_bf16 v[208:223], a[36:39], v[72:75], v[208:223]
    buffer_load_dwordx4 v[116:119], v21, s[36:39], s68 offen offset:1024 sc1
    v_xor_b32 v19, 0x1000, v15
    v_bfe_u32 v36, v1, 3, 2
    v_and_b32 v37, 7, v1
    s_waitcnt vmcnt(14)
    v_mfma_f32_32x32x16_bf16 v[224:239], a[32:35], v[76:79], v[224:239]
    v_lshl_add_u32 v36, v36, 4, v37
    v_lshrrev_b32 v37, 5, v1
    v_lshlrev_b32 v37, 1, v37
    v_mfma_f32_32x32x16_bf16 v[240:255], a[36:39], v[76:79], v[240:255]
    buffer_load_dwordx4 v[120:123], v14, s[36:39], s68 offen offset:2048 sc1
    v_bfe_u32 v9, v1, 1, 3
    v_xor_b32 v9, v9, v37
    v_lshlrev_b32 v9, 4, v9
    s_waitcnt vmcnt(13)
    v_mfma_f32_32x32x16_bf16 v[192:207], a[40:43], v[80:83], v[192:207]
    v_lshl_add_u32 v9, v36, 7, v9
    s_andn2_b32 s60, 1, s44
    s_andn2_b32 s61, 2, s44
    s_lshl3_add_u32 s60, s61, s60
    s_lshl_b32 s60, s60, 6
    v_xor_b32 v9, s60, v9
    v_add_u32 v9, 140288, v9
    v_mfma_f32_32x32x16_bf16 v[208:223], a[44:47], v[80:83], v[208:223]
    buffer_load_dwordx4 v[124:127], v21, s[36:39], s68 offen offset:2048 sc1
    v_xor_b32 v10, 16, v9
    v_and_b32 v11, 1, v36
    v_and_b32 v36, 0x3e, v36
    s_waitcnt vmcnt(13)
    v_mfma_f32_32x32x16_bf16 v[224:239], a[40:43], v[84:87], v[224:239]
    v_add_lshl_u32 v37, v37, v11, 4
    v_lshl_add_u32 v3, v36, 10, v37
    v_mfma_f32_32x32x16_bf16 v[240:255], a[44:47], v[84:87], v[240:255]
    buffer_load_dwordx4 v[128:131], v14, s[36:39], s68 offen offset:3072 sc1
    v_lshrrev_b32 v27, 4, v1
    v_and_b32 v28, 15, v1
    s_lshl_b32 s60, s44, 2
    s_waitcnt vmcnt(13)
    v_mfma_f32_32x32x16_bf16 v[192:207], a[48:51], v[88:91], v[192:207]
    v_xor_b32 v28, s60, v28
    v_lshlrev_b32 v28, 4, v28
    v_lshl_add_u32 v34, v27, 13, v28
    v_mfma_f32_32x32x16_bf16 v[208:223], a[52:55], v[88:91], v[208:223]
    buffer_load_dwordx4 v[132:135], v21, s[36:39], s68 offen offset:3072 sc1
    v_xor_b32 v35, 32, v34
    s_mul_i32 s61, s44, 2176
    s_add_u32 s61, s61, 152576
    s_waitcnt vmcnt(13)
    v_mfma_f32_32x32x16_bf16 v[224:239], a[48:51], v[92:95], v[224:239]
    v_mul_u32_u24 v27, 272, v27
    v_add3_u32 v36, v27, v28, s61
    v_xor_b32 v28, 32, v28
    v_mfma_f32_32x32x16_bf16 v[240:255], a[52:55], v[92:95], v[240:255]
    s_add_u32 s68, s68, 4096
    buffer_load_dwordx4 v[136:139], v14, s[36:39], s68 offen offset:0 sc1
    v_add3_u32 v37, v27, v28, s61
    v_bfe_u32 v27, v1, 3, 2
    v_bfe_u32 v28, v1, 2, 1
    s_waitcnt vmcnt(13)
    v_mfma_f32_32x32x16_bf16 v[192:207], a[56:59], v[96:99], v[192:207]
    v_lshl_add_u32 v27, v27, 2, v28
    v_lshrrev_b32 v28, 5, v1
    v_lshlrev_b32 v27, 4, v27
    v_mfma_f32_32x32x16_bf16 v[208:223], a[60:63], v[96:99], v[208:223]
    buffer_load_dwordx4 v[140:143], v21, s[36:39], s68 offen offset:0 sc1
    v_mul_u32_u24 v28, 2112, v28
    v_xor_b32 v27, v27, v28
    v_and_b32 v28, 3, v1
    s_waitcnt vmcnt(13)
    v_mfma_f32_32x32x16_bf16 v[224:239], a[56:59], v[100:103], v[224:239]
    v_lshl_add_u32 v27, v28, 2, v27
    s_andn2_b32 s60, 1, s44
    s_mul_i32 s60, s60, 4224
    s_andn2_b32 s61, 2, s44
    s_lshl4_add_u32 s60, s61, s60
    s_add_u32 s60, s60, 131072
    v_xor_b32 v30, s60, v27
    v_xor_b32 v31, 32, v30
    v_mfma_f32_32x32x16_bf16 v[240:255], a[60:63], v[100:103], v[240:255]
    buffer_load_dwordx4 v[144:147], v14, s[36:39], s68 offen offset:1024 sc1
    s_add_u32 s60, s71, 131072
    v_add_u32 v29, s60, v2
    s_waitcnt vmcnt(13)
    v_mfma_f32_32x32x16_bf16 v[192:207], a[64:67], v[104:107], v[192:207]
    v_mfma_f32_32x32x16_bf16 v[208:223], a[68:71], v[104:107], v[208:223]
    buffer_load_dwordx4 v[148:151], v21, s[36:39], s68 offen offset:1024 sc1
    s_waitcnt vmcnt(12)
    v_mfma_f32_32x32x16_bf16 v[224:239], a[64:67], v[108:111], v[224:239]
    v_mfma_f32_32x32x16_bf16 v[240:255], a[68:71], v[108:111], v[240:255]
    v_cmp_ne_u64 vcc, s[42:43], v[24:25]
    s_cbranch_vccnz L_slow_h1
L_back_h1:
    s_waitcnt vmcnt(10)
    v_mfma_f32_32x32x16_bf16 v[192:207], a[72:75], v[112:115], v[192:207]
    v_mfma_f32_32x32x16_bf16 v[208:223], a[76:79], v[112:115], v[208:223]
    s_add_u32 s68, s68, 45056
    buffer_load_dwordx4 v[152:155], v14, s[36:39], s68 offen offset:0 sc1
    s_waitcnt vmcnt(9)
    v_mfma_f32_32x32x16_bf16 v[224:239], a[72:75], v[116:119], v[224:239]
    buffer_load_dwordx4 v[156:159], v14, s[36:39], s68 offen offset:1024 sc1
    v_mfma_f32_32x32x16_bf16 v[240:255], a[76:79], v[116:119], v[240:255]
    s_waitcnt vmcnt(9)
    v_mfma_f32_32x32x16_bf16 v[192:207], a[80:83], v[120:123], v[192:207]
    buffer_load_dwordx4 v[160:163], v14, s[36:39], s68 offen offset:2048 sc1
    v_mfma_f32_32x32x16_bf16 v[208:223], a[84:87], v[120:123], v[208:223]
    v_and_b32 v18, 0x1f0, v2
    s_lshl_b32 s74, s47, 9
    s_waitcnt vmcnt(9)
    v_mfma_f32_32x32x16_bf16 v[224:239], a[80:83], v[124:127], v[224:239]
    buffer_load_dwordx4 v[164:167], v14, s[36:39], s68 offen offset:3072 sc1
    s_add_u32 s74, s74, 13107200
    s_lshl_b32 s3, s44, 14
    s_sub_u32 s70, s70, s3
    v_mfma_f32_32x32x16_bf16 v[240:255], a[84:87], v[124:127], v[240:255]
    s_andn2_b32 s3, 2, s44
    s_lshl_b32 s3, s3, 12
    s_add_u32 s70, s70, s3
    s_andn2_b32 s3, 1, s44
    s_lshl_b32 s3, s3, 6
    s_add_u32 s70, s70, s3
    s_waitcnt vmcnt(9)
    v_mfma_f32_32x32x16_bf16 v[192:207], a[88:91], v[128:131], v[192:207]
    buffer_load_dwordx4 v[124:127], v18, s[36:39], s74 offen sc1
    v_mfma_f32_32x32x16_bf16 v[208:223], a[92:95], v[128:131], v[208:223]
    s_waitcnt vmcnt(9)
    v_mfma_f32_32x32x16_bf16 v[224:239], a[88:91], v[132:135], v[224:239]
    s_add_u32 s68, s68, 4096
    buffer_load_dwordx4 v[168:171], v14, s[36:39], s68 offen offset:0 sc1
    v_mfma_f32_32x32x16_bf16 v[240:255], a[92:95], v[132:135], v[240:255]
    buffer_load_dwordx4 v[172:175], v14, s[36:39], s68 offen offset:1024 sc1
    s_waitcnt vmcnt(10)
    v_mfma_f32_32x32x16_bf16 v[192:207], a[96:99], v[136:139], v[192:207]
    v_mfma_f32_32x32x16_bf16 v[208:223], a[100:103], v[136:139], v[208:223]
    buffer_load_dwordx4 v[176:179], v14, s[36:39], s68 offen offset:2048 sc1
    s_waitcnt vmcnt(10)
    v_mfma_f32_32x32x16_bf16 v[224:239], a[96:99], v[140:143], v[224:239]
    v_mfma_f32_32x32x16_bf16 v[240:255], a[100:103], v[140:143], v[240:255]
    buffer_load_dwordx4 v[180:183], v14, s[36:39], s68 offen offset:3072 sc1
    s_waitcnt vmcnt(10)
    v_mfma_f32_32x32x16_bf16 v[192:207], a[104:107], v[144:147], v[192:207]
    v_mfma_f32_32x32x16_bf16 v[208:223], a[108:111], v[144:147], v[208:223]
    s_add_u32 s68, s68, 4096
    buffer_load_dwordx4 v[184:187], v14, s[36:39], s68 offen offset:0 sc1
    s_waitcnt vmcnt(10)
    v_mfma_f32_32x32x16_bf16 v[224:239], a[104:107], v[148:151], v[224:239]
    v_mfma_f32_32x32x16_bf16 v[240:255], a[108:111], v[148:151], v[240:255]
    buffer_load_dwordx4 v[188:191], v14, s[36:39], s68 offen offset:1024 sc1
    s_waitcnt vmcnt(10)
    v_mfma_f32_32x32x16_bf16 v[192:207], a[112:115], v[152:155], v[192:207]
    buffer_load_dwordx4 v[40:43], v14, s[36:39], s68 offen offset:2048 sc1
    v_mfma_f32_32x32x16_bf16 v[208:223], a[116:119], v[152:155], v[208:223]
    s_waitcnt vmcnt(10)
    v_mfma_f32_32x32x16_bf16 v[192:207], a[120:123], v[156:159], v[192:207]
    buffer_load_dwordx4 v[44:47], v14, s[36:39], s68 offen offset:3072 sc1
    v_mfma_f32_32x32x16_bf16 v[208:223], a[124:127], v[156:159], v[208:223]
    s_waitcnt vmcnt(10)
    v_mfma_f32_32x32x16_bf16 v[192:207], a[128:131], v[160:163], v[192:207]
    s_add_u32 s68, s68, 4096
    buffer_load_dwordx4 v[48:51], v14, s[36:39], s68 offen offset:0 sc1
    v_mfma_f32_32x32x16_bf16 v[208:223], a[132:135], v[160:163], v[208:223]
    s_waitcnt vmcnt(10)
    v_mfma_f32_32x32x16_bf16 v[192:207], a[136:139], v[164:167], v[192:207]
    buffer_load_dwordx4 v[52:55], v14, s[36:39], s68 offen offset:1024 sc1
    v_mfma_f32_32x32x16_bf16 v[208:223], a[140:143], v[164:167], v[208:223]
    s_waitcnt vmcnt(9)
    v_mfma_f32_32x32x16_bf16 v[192:207], a[144:147], v[168:171], v[192:207]
    buffer_load_dwordx4 v[160:163], v34, s[36:39], s92 offen sc1
    ds_read_b128 v[112:115], v9
    v_mfma_f32_32x32x16_bf16 v[208:223], a[148:151], v[168:171], v[208:223]
    buffer_load_dwordx4 v[164:167], v35, s[36:39], s93 offen sc1
    ds_read_b128 v[116:119], v10
    s_waitcnt vmcnt(10)
    v_mfma_f32_32x32x16_bf16 v[192:207], a[152:155], v[172:175], v[192:207]
    v_cmp_ne_u64 vcc, s[42:43], v[126:127]
    s_cbranch_vccnz L_slow_st
L_back_st:
    s_bitcmp1_b32 s44, 1
    s_cselect_b64 vcc, -1, 0
    v_cndmask_b32 v124, v125, v124, vcc
    v_lshlrev_b32 v121, 16, v124
    v_and_b32 v120, 0xffff0000, v124
    v_mfma_f32_32x32x16_bf16 v[208:223], a[156:159], v[172:175], v[208:223]
    s_add_u32 s68, s68, 4294955008
    buffer_load_dwordx4 v[56:59], v21, s[36:39], s68 offen offset:0 sc1
    v_rcp_f32 v121, v121
    s_nop 0
    v_mul_f32 v120, v120, v121
    s_waitcnt vmcnt(10)
    v_mfma_f32_32x32x16_bf16 v[192:207], a[160:163], v[176:179], v[192:207]
    buffer_load_dwordx4 v[60:63], v21, s[36:39], s68 offen offset:1024 sc1
    s_waitcnt lgkmcnt(1)
    v_lshlrev_b32 v128, 16, v112
    v_and_b32 v129, 0xffff0000, v112
    v_fma_f32 v144, v128, v121, -v120
    v_mfma_f32_32x32x16_bf16 v[208:223], a[164:167], v[176:179], v[208:223]
    v_fma_f32 v145, v129, v121, -v120
    v_lshlrev_b32 v130, 16, v113
    s_waitcnt vmcnt(10)
    v_mfma_f32_32x32x16_bf16 v[192:207], a[168:171], v[180:183], v[192:207]
    buffer_load_dwordx4 v[64:67], v21, s[36:39], s68 offen offset:2048 sc1
    v_and_b32 v131, 0xffff0000, v113
    v_fma_f32 v146, v130, v121, -v120
    v_fma_f32 v147, v131, v121, -v120
    v_mfma_f32_32x32x16_bf16 v[208:223], a[172:175], v[180:183], v[208:223]
    buffer_load_dwordx4 v[68:71], v21, s[36:39], s68 offen offset:3072 sc1
    v_lshlrev_b32 v132, 16, v114
    v_and_b32 v133, 0xffff0000, v114
    s_waitcnt vmcnt(11)
    v_mfma_f32_32x32x16_bf16 v[192:207], a[176:179], v[184:187], v[192:207]
    v_fma_f32 v148, v132, v121, -v120
    v_fma_f32 v149, v133, v121, -v120
    v_lshlrev_b32 v134, 16, v115
    v_mfma_f32_32x32x16_bf16 v[208:223], a[180:183], v[184:187], v[208:223]
    s_add_u32 s68, s68, 4096
    buffer_load_dwordx4 v[72:75], v21, s[36:39], s68 offen offset:0 sc1
    v_and_b32 v135, 0xffff0000, v115
    v_fma_f32 v150, v134, v121, -v120
    s_waitcnt vmcnt(11)
    v_mfma_f32_32x32x16_bf16 v[192:207], a[184:187], v[188:191], v[192:207]
    buffer_load_dwordx4 v[76:79], v21, s[36:39], s68 offen offset:1024 sc1
    v_fma_f32 v151, v135, v121, -v120
    s_waitcnt lgkmcnt(0)
    v_lshlrev_b32 v136, 16, v116
    v_and_b32 v137, 0xffff0000, v116
    v_mfma_f32_32x32x16_bf16 v[208:223], a[188:191], v[188:191], v[208:223]
    v_fma_f32 v152, v136, v121, -v120
    v_fma_f32 v153, v137, v121, -v120
    s_waitcnt vmcnt(11)
    v_mfma_f32_32x32x16_bf16 v[192:207], a[192:195], v[40:43], v[192:207]
    buffer_load_dwordx4 v[80:83], v21, s[36:39], s68 offen offset:2048 sc1
    ds_read_b128 v[168:171], v36
    v_lshlrev_b32 v138, 16, v117
    v_and_b32 v139, 0xffff0000, v117
    v_fma_f32 v154, v138, v121, -v120
    v_mfma_f32_32x32x16_bf16 v[208:223], a[196:199], v[40:43], v[208:223]
    ds_read_b128 v[172:175], v37 offset:1088
    v_fma_f32 v155, v139, v121, -v120
    v_lshlrev_b32 v140, 16, v118
    s_waitcnt vmcnt(11)
    v_mfma_f32_32x32x16_bf16 v[192:207], a[200:203], v[44:47], v[192:207]
    buffer_load_dwordx4 v[84:87], v21, s[36:39], s68 offen offset:3072 sc1
    v_and_b32 v141, 0xffff0000, v118
    v_fma_f32 v156, v140, v121, -v120
    v_fma_f32 v157, v141, v121, -v120
    v_mfma_f32_32x32x16_bf16 v[208:223], a[204:207], v[44:47], v[208:223]
    s_add_u32 s68, s68, 4096
    buffer_load_dwordx4 v[88:91], v21, s[36:39], s68 offen offset:0 sc1
    v_lshlrev_b32 v142, 16, v119
    v_and_b32 v143, 0xffff0000, v119
    s_waitcnt vmcnt(12)
    v_mfma_f32_32x32x16_bf16 v[192:207], a[208:211], v[48:51], v[192:207]
    s_waitcnt vmcnt(10) lgkmcnt(1)
    v_xad_u32 v160, v168, -1, v160
    v_xad_u32 v161, v169, -1, v161
    v_xad_u32 v162, v170, -1, v162
    v_xad_u32 v163, v171, -1, v163
    v_fma_f32 v158, v142, v121, -v120
    v_fma_f32 v159, v143, v121, -v120
    v_mfma_f32_32x32x16_bf16 v[208:223], a[212:215], v[48:51], v[208:223]
    buffer_load_dwordx4 v[92:95], v21, s[36:39], s68 offen offset:1024 sc1
    s_waitcnt vmcnt(10) lgkmcnt(0)
    v_xad_u32 v164, v172, -1, v164
    v_xad_u32 v165, v173, -1, v165
    v_xad_u32 v166, v174, -1, v166
    v_xad_u32 v167, v175, -1, v167
    v_mfma_f32_32x32x16_bf16 v[192:207], a[216:219], v[52:55], v[192:207]
    buffer_load_dwordx4 v[96:99], v21, s[36:39], s68 offen offset:2048 sc1
    v_max3_u32 v27, v160, v161, v162
    v_max3_u32 v28, v163, v164, v165
    v_max3_u32 v27, v27, v166, v167
    v_max_u32 v27, v27, v28
    v_mfma_f32_32x32x16_bf16 v[208:223], a[220:223], v[52:55], v[208:223]
    v_cmp_eq_u32 vcc, -1, v27
    s_cbranch_vccnz L_slow_y
L_back_y:
    ds_write_b128 v29, v[160:163]
    ds_write_b128 v29, v[164:167] offset:1024
    s_waitcnt vmcnt(10)
    v_mfma_f32_32x32x16_bf16 v[224:239], a[112:115], v[56:59], v[224:239]
    buffer_load_dwordx4 v[100:103], v21, s[36:39], s68 offen offset:3072 sc1
    ds_write_b128 v15, v[192:195] offset:0
    v_mfma_f32_32x32x16_bf16 v[240:255], a[116:119], v[56:59], v[240:255]
    s_add_u32 s68, s68, 4096
    buffer_load_dwordx4 v[104:107], v21, s[36:39], s68 offen offset:0 sc1
    ds_write_b128 v15, v[196:199] offset:1024
    s_waitcnt vmcnt(11)
    v_mfma_f32_32x32x16_bf16 v[224:239], a[120:123], v[60:63], v[224:239]
    s_waitcnt lgkmcnt(2)
    s_barrier
    ds_read_b32 v176, v30 offset:0
    ds_read_b32 v177, v30 offset:256
    ds_read_b32 v178, v30 offset:512
    s_waitcnt vmcnt(10)
    v_mfma_f32_32x32x16_bf16 v[224:239], a[128:131], v[64:67], v[224:239]
    buffer_load_dwordx4 v[108:111], v21, s[36:39], s68 offen offset:1024 sc1
    ds_read_b32 v179, v30 offset:768
    ds_read_b32 v180, v31 offset:1024
    ds_read_b32 v181, v31 offset:1280
    ds_read_b32 v182, v31 offset:1536
    ds_write_b128 v15, v[200:203] offset:2048
    v_mfma_f32_32x32x16_bf16 v[240:255], a[124:127], v[60:63], v[240:255]
    ds_read_b32 v183, v31 offset:1792
    s_waitcnt vmcnt(10)
    v_mfma_f32_32x32x16_bf16 v[224:239], a[136:139], v[68:71], v[224:239]
    s_waitcnt lgkmcnt(8)
    v_lshlrev_b32 v32, 16, v176
    v_and_b32 v33, 0xffff0000, v176
    v_fma_f32 v144, v144, v32, v128
    ds_write_b128 v15, v[204:207] offset:3072
    s_waitcnt vmcnt(9)
    v_mfma_f32_32x32x16_bf16 v[224:239], a[144:147], v[72:75], v[224:239]
    v_fma_f32 v145, v145, v33, v129
    s_waitcnt lgkmcnt(8)
    v_lshlrev_b32 v32, 16, v177
    v_and_b32 v33, 0xffff0000, v177
    ds_write_b128 v15, v[208:211] offset:16384
    s_waitcnt vmcnt(8)
    v_mfma_f32_32x32x16_bf16 v[224:239], a[152:155], v[76:79], v[224:239]
    v_fma_f32 v146, v146, v32, v130
    v_fma_f32 v147, v147, v33, v131
    s_waitcnt lgkmcnt(8)
    v_lshlrev_b32 v32, 16, v178
    v_mfma_f32_32x32x16_bf16 v[240:255], a[132:135], v[64:67], v[240:255]
    v_and_b32 v33, 0xffff0000, v178
    v_fma_f32 v148, v148, v32, v132
    v_fma_f32 v149, v149, v33, v133
    ds_write_b128 v15, v[212:215] offset:17408
    s_waitcnt vmcnt(7)
    v_mfma_f32_32x32x16_bf16 v[224:239], a[160:163], v[80:83], v[224:239]
    s_waitcnt lgkmcnt(8)
    v_lshlrev_b32 v32, 16, v179
    v_and_b32 v33, 0xffff0000, v179
    v_fma_f32 v150, v150, v32, v134
    s_waitcnt vmcnt(6)
    v_mfma_f32_32x32x16_bf16 v[224:239], a[168:171], v[84:87], v[224:239]
    v_fma_f32 v151, v151, v33, v135
    s_waitcnt lgkmcnt(7)
    v_lshlrev_b32 v32, 16, v180
    v_and_b32 v33, 0xffff0000, v180
    ds_write_b128 v15, v[216:219] offset:18432
    v_mfma_f32_32x32x16_bf16 v[240:255], a[140:143], v[68:71], v[240:255]
    v_fma_f32 v152, v152, v32, v136
    v_fma_f32 v153, v153, v33, v137
    s_waitcnt lgkmcnt(7)
    v_lshlrev_b32 v32, 16, v181
    ds_write_b128 v15, v[220:223] offset:19456
    s_waitcnt vmcnt(5)
    v_mfma_f32_32x32x16_bf16 v[224:239], a[176:179], v[88:91], v[224:239]
    v_and_b32 v33, 0xffff0000, v181
    v_fma_f32 v154, v154, v32, v138
    v_fma_f32 v155, v155, v33, v139
    s_waitcnt vmcnt(4)
    v_mfma_f32_32x32x16_bf16 v[224:239], a[184:187], v[92:95], v[224:239]
    s_waitcnt lgkmcnt(7)
    v_lshlrev_b32 v32, 16, v182
    v_and_b32 v33, 0xffff0000, v182
    v_fma_f32 v156, v156, v32, v140
    s_waitcnt lgkmcnt(0)
    s_barrier
    ds_read_b128 v[192:195], v16 offset:0
    ds_read_b128 v[196:199], v16 offset:1024
    ds_read_b128 v[200:203], v16 offset:2048
    s_waitcnt vmcnt(3)
    v_mfma_f32_32x32x16_bf16 v[224:239], a[192:195], v[96:99], v[224:239]
    v_fma_f32 v157, v157, v33, v141
    v_lshlrev_b32 v32, 16, v183
    v_and_b32 v33, 0xffff0000, v183
    ds_read_b128 v[204:207], v16 offset:3072
    ds_read_b128 v[208:211], v17 offset:16384
    ds_read_b128 v[212:215], v17 offset:17408
    ds_read_b128 v[216:219], v17 offset:18432
    v_mfma_f32_32x32x16_bf16 v[240:255], a[148:151], v[72:75], v[240:255]
    v_fma_f32 v158, v158, v32, v142
    v_fma_f32 v159, v159, v33, v143
    ds_read_b128 v[220:223], v17 offset:19456
    s_waitcnt vmcnt(2)
    v_mfma_f32_32x32x16_bf16 v[224:239], a[200:203], v[100:103], v[224:239]
    s_waitcnt lgkmcnt(7)
    v_fmac_f32 v144, v192, v121
    v_fmac_f32 v145, v193, v121
    v_fmac_f32 v146, v194, v121
    v_fmac_f32 v147, v195, v121
    s_waitcnt vmcnt(1)
    v_mfma_f32_32x32x16_bf16 v[224:239], a[208:211], v[104:107], v[224:239]
    s_waitcnt lgkmcnt(6)
    v_fmac_f32 v148, v196, v121
    v_fmac_f32 v149, v197, v121
    v_fmac_f32 v150, v198, v121
    v_fmac_f32 v151, v199, v121
    s_waitcnt vmcnt(0)
    v_mfma_f32_32x32x16_bf16 v[224:239], a[216:219], v[108:111], v[224:239]
    s_waitcnt lgkmcnt(5)
    v_fmac_f32 v152, v200, v121
    v_fmac_f32 v153, v201, v121
    v_fmac_f32 v154, v202, v121
    v_fmac_f32 v155, v203, v121
    v_mfma_f32_32x32x16_bf16 v[240:255], a[156:159], v[76:79], v[240:255]
    s_waitcnt lgkmcnt(4)
    v_fmac_f32 v156, v204, v121
    v_fmac_f32 v157, v205, v121
    v_fmac_f32 v158, v206, v121
    v_fmac_f32 v159, v207, v121
    v_mfma_f32_32x32x16_bf16 v[240:255], a[164:167], v[80:83], v[240:255]
    ds_write_b128 v15, v[224:227] offset:32768
    s_waitcnt lgkmcnt(4)
    v_fmac_f32 v144, v208, v121
    v_fmac_f32 v145, v209, v121
    v_fmac_f32 v146, v210, v121
    v_fmac_f32 v147, v211, v121
    v_mfma_f32_32x32x16_bf16 v[240:255], a[172:175], v[84:87], v[240:255]
    ds_write_b128 v15, v[228:231] offset:33792
    s_waitcnt lgkmcnt(4)
    v_fmac_f32 v148, v212, v121
    v_fmac_f32 v149, v213, v121
    v_fmac_f32 v150, v214, v121
    v_fmac_f32 v151, v215, v121
    v_mfma_f32_32x32x16_bf16 v[240:255], a[180:183], v[88:91], v[240:255]
    s_waitcnt lgkmcnt(3)
    v_fmac_f32 v152, v216, v121
    v_fmac_f32 v153, v217, v121
    v_fmac_f32 v154, v218, v121
    v_fmac_f32 v155, v219, v121
    v_mfma_f32_32x32x16_bf16 v[240:255], a[188:191], v[92:95], v[240:255]
    ds_write_b128 v15, v[232:235] offset:34816
    s_waitcnt lgkmcnt(3)
    v_fmac_f32 v156, v220, v121
    v_fmac_f32 v157, v221, v121
    v_fmac_f32 v158, v222, v121
    v_fmac_f32 v159, v223, v121
    v_mfma_f32_32x32x16_bf16 v[240:255], a[196:199], v[96:99], v[240:255]
    v_mfma_f32_32x32x16_bf16 v[240:255], a[204:207], v[100:103], v[240:255]
    ds_write_b128 v15, v[236:239] offset:35840
    v_mfma_f32_32x32x16_bf16 v[240:255], a[212:215], v[104:107], v[240:255]
    v_mfma_f32_32x32x16_bf16 v[240:255], a[220:223], v[108:111], v[240:255]
    s_waitcnt lgkmcnt(0)
    s_barrier
    ds_read_b128 v[224:227], v19 offset:32768
    ds_read_b128 v[228:231], v19 offset:33792
    ds_read_b128 v[232:235], v19 offset:34816
    ds_read_b128 v[236:239], v19 offset:35840
    s_nop 5
    v_pk_fma_f32 v[144:145], v[240:241], v[120:121], v[144:145] op_sel:[0,1,0] op_sel_hi:[1,1,1]
    v_pk_fma_f32 v[146:147], v[242:243], v[120:121], v[146:147] op_sel:[0,1,0] op_sel_hi:[1,1,1]
    v_pk_fma_f32 v[148:149], v[244:245], v[120:121], v[148:149] op_sel:[0,1,0] op_sel_hi:[1,1,1]
    v_pk_fma_f32 v[150:151], v[246:247], v[120:121], v[150:151] op_sel:[0,1,0] op_sel_hi:[1,1,1]
    v_pk_fma_f32 v[152:153], v[248:249], v[120:121], v[152:153] op_sel:[0,1,0] op_sel_hi:[1,1,1]
    v_pk_fma_f32 v[154:155], v[250:251], v[120:121], v[154:155] op_sel:[0,1,0] op_sel_hi:[1,1,1]
    v_pk_fma_f32 v[156:157], v[252:253], v[120:121], v[156:157] op_sel:[0,1,0] op_sel_hi:[1,1,1]
    v_pk_fma_f32 v[158:159], v[254:255], v[120:121], v[158:159] op_sel:[0,1,0] op_sel_hi:[1,1,1]
    s_waitcnt lgkmcnt(3)
    v_pk_fma_f32 v[144:145], v[224:225], v[120:121], v[144:145] op_sel:[0,1,0] op_sel_hi:[1,1,1]
    v_pk_fma_f32 v[146:147], v[226:227], v[120:121], v[146:147] op_sel:[0,1,0] op_sel_hi:[1,1,1]
    s_waitcnt lgkmcnt(2)
    v_pk_fma_f32 v[148:149], v[228:229], v[120:121], v[148:149] op_sel:[0,1,0] op_sel_hi:[1,1,1]
    v_pk_fma_f32 v[150:151], v[230:231], v[120:121], v[150:151] op_sel:[0,1,0] op_sel_hi:[1,1,1]
    v_cvt_pk_bf16_f32 v128, v144, v145
    v_cvt_pk_bf16_f32 v129, v146, v147
    v_cvt_pk_bf16_f32 v130, v148, v149
    v_cvt_pk_bf16_f32 v131, v150, v151
    s_mov_b32 vcc_lo, 0x55555555
    s_mov_b32 vcc_hi, 0x55555555
    s_waitcnt lgkmcnt(1)
    v_pk_fma_f32 v[152:153], v[232:233], v[120:121], v[152:153] op_sel:[0,1,0] op_sel_hi:[1,1,1]
    v_pk_fma_f32 v[154:155], v[234:235], v[120:121], v[154:155] op_sel:[0,1,0] op_sel_hi:[1,1,1]
    s_waitcnt lgkmcnt(0)
    v_pk_fma_f32 v[156:157], v[236:237], v[120:121], v[156:157] op_sel:[0,1,0] op_sel_hi:[1,1,1]
    v_pk_fma_f32 v[158:159], v[238:239], v[120:121], v[158:159] op_sel:[0,1,0] op_sel_hi:[1,1,1]
    v_cvt_pk_bf16_f32 v132, v152, v153
    v_cvt_pk_bf16_f32 v133, v154, v155
    v_cvt_pk_bf16_f32 v134, v156, v157
    v_cvt_pk_bf16_f32 v135, v158, v159
    v_cndmask_b32_dpp v136, v132, v128, vcc quad_perm:[1,0,3,2] row_mask:0xf bank_mask:0xf
    v_cndmask_b32_dpp v137, v133, v129, vcc quad_perm:[1,0,3,2] row_mask:0xf bank_mask:0xf
    v_cndmask_b32_dpp v138, v134, v130, vcc quad_perm:[1,0,3,2] row_mask:0xf bank_mask:0xf
    v_cndmask_b32_dpp v139, v135, v131, vcc quad_perm:[1,0,3,2] row_mask:0xf bank_mask:0xf
    buffer_store_dwordx4 v[136:139], v3, s[32:35], s70 offen offset:0
    s_not_b64 vcc, vcc
    v_cndmask_b32_dpp v140, v128, v132, vcc quad_perm:[1,0,3,2] row_mask:0xf bank_mask:0xf
    v_cndmask_b32_dpp v141, v129, v133, vcc quad_perm:[1,0,3,2] row_mask:0xf bank_mask:0xf
    v_cndmask_b32_dpp v142, v130, v134, vcc quad_perm:[1,0,3,2] row_mask:0xf bank_mask:0xf
    v_cndmask_b32_dpp v143, v131, v135, vcc quad_perm:[1,0,3,2] row_mask:0xf bank_mask:0xf
    buffer_store_dwordx4 v[140:143], v3, s[32:35], s70 offen offset:1024
L_end:
    s_endpgm
.p2alignl 12, 0xbf810000
L_spare:
    s_lshr_b32 s60, s45, 1
    s_lshl_b32 s60, s60, 5
    s_add_u32 s60, s60, s46
    s_lshl2_add_u32 s60, s60, s44
    s_and_b32 s61, s45, 1
    s_lshl1_add_u32 s60, s60, s61
    s_mul_i32 s94, s60, 1792
    v_min_u32 v32, 13, v1
    v_lshlrev_b32 v32, 7, v32
    v_and_b32 v33, 15, v1
    v_lshlrev_b32 v33, 10, v33
    s_waitcnt lgkmcnt(0)
    buffer_load_dword a254, v32, s[24:27], s94 offen
    v_add_u32 v21, 7168, v20
    s_and_b32 s60, s44, 1
    s_mul_i32 s60, s60, 896
    s_lshr_b32 s61, s44, 1
    s_lshl_b32 s61, s61, 6
    s_add_u32 s60, s60, s61
    s_and_b32 s61, s46, 3
    s_lshl4_add_u32 s60, s61, s60
    s_lshl3_add_u32 s60, s60, s45
    s_lshl_b32 s53, s60, 7
    s_lshl2_add_u32 s60, s45, s61
    s_lshl2_add_u32 s60, s60, s44
    s_mul_i32 s55, s60, 14336
    s_add_u32 s55, s55, 14680064
    s_lshl_b32 s75, s44, 14
    s_add_u32 m0, s75, 0
    s_nop 0
    buffer_load_dwordx4 v20, s[28:31], s53 offen lds
    v_lshrrev_b32 v30, 5, v1
    v_lshlrev_b32 v30, 5, v30
    v_xor_b32 v96, v3, v30
    v_xor_b32 v97, 64, v96
    v_add_u32 v97, 7168, v97
    s_lshl_b32 s60, s47, 16
    s_lshl_b32 s61, s44, 14
    s_lshl_b32 s62, s48, 7
    s_add_u32 s60, s60, s62
    s_add_u32 s70, s60, s61
    s_lshl_b32 s61, s44, 10
    buffer_load_dwordx4 v21, s[28:31], s53 offen offset:1024 lds
    s_add_u32 s53, s53, 131072
    s_add_u32 m0, s75, 2048
    s_add_u32 s60, s60, s61
    s_sub_u32 s60, s60, 4096
    v_xor_b32 v98, 6, v28
    v_lshlrev_b32 v98, 4, v98
    v_add_u32 v98, s60, v98
    s_lshl_b32 s71, s44, 11
    s_lshl_b32 s72, s44, 7
    s_lshl2_add_u32 s101, s62, s72
    v_and_b32 v99, 15, v1
    v_lshlrev_b32 v99, 3, v99
    buffer_load_dword a253, v33, s[4:7], s70 offen
    buffer_load_dwordx4 v20, s[28:31], s53 offen lds
    s_lshr_b32 s60, s44, 1
    s_lshl1_add_u32 s60, s2, s60
    s_lshl_b32 s73, s60, 12
    s_lshl_b32 s61, s2, 2
    s_mov_b32 s62, 13172736
    s_load_dwordx2 s[42:43], s[36:37], s62
    s_load_dwordx2 s[58:59], s[20:21], s73
    s_load_dword s56, s[40:41], s61
    s_and_b32 s61, s44, 1
    s_lshl_b32 s61, s61, 2
    s_sub_u32 s73, s73, s61
    buffer_load_dwordx4 v21, s[28:31], s53 offen offset:1024 lds
    s_add_u32 s53, s53, 131072
    s_add_u32 m0, s75, 4096
    s_add_u32 s73, s73, 8
    s_lshl2_add_u32 s69, s2, s44
    s_lshl_b32 s69, s69, 11
    s_lshl_b32 s65, s2, 7
    s_add_u32 s65, s65, 12582912
    s_cmp_eq_u32 s44, 0
    s_cselect_b32 s65, s65, 16777216
    v_lshlrev_b32 v2, 4, v1
    v_lshrrev_b32 v29, 4, v1
    v_lshrrev_b32 v30, 5, v1
    v_bfe_u32 v32, v1, 2, 2
    buffer_load_dwordx4 v20, s[28:31], s53 offen lds
    v_and_b32 v33, 3, v1
    v_bfe_u32 v35, v1, 3, 1
    v_lshlrev_b32 v35, 6, v35
    v_lshl_add_u32 v35, v32, 7, v35
    v_and_b32 v34, 1, v29
    v_lshl_add_u32 v35, v34, 4, v35
    v_and_b32 v34, 1, v33
    v_lshrrev_b32 v33, 1, v33
    v_lshl_add_u32 v35, v34, 5, v35
    s_and_b32 s60, s46, 1
    s_lshl_b32 s60, s60, 6
    v_xor_b32 v35, s60, v35
    v_lshl_add_u32 v35, v33, 3, v35
    buffer_load_dwordx4 v21, s[28:31], s53 offen offset:1024 lds
    s_add_u32 s53, s53, 131072
    s_add_u32 m0, s75, 6144
    v_lshl_add_u32 v12, v30, 9, v35
    v_add_u32 v12, s75, v12
    v_xor_b32 v13, 64, v12
    v_lshrrev_b32 v27, 4, v1
    v_bfe_u32 v28, v1, 2, 2
    v_and_b32 v29, 3, v1
    v_lshrrev_b32 v30, 2, v1
    v_lshlrev_b32 v30, 9, v30
    v_lshl_add_u32 v30, v29, 3, v30
    v_xor_b32 v31, s44, v28
    v_lshl_add_u32 v31, v31, 5, v30
    buffer_load_dwordx4 v20, s[28:31], s53 offen lds
    v_add_u32 v254, 132096, v31
    v_add_u32 v32, 3, v28
    v_and_b32 v32, 3, v32
    v_xor_b32 v32, s44, v32
    v_lshl_add_u32 v32, v32, 5, v30
    v_add_u32 v255, 131584, v32
    s_mul_i32 s61, s44, 2176
    s_add_u32 s61, s61, 152576
    v_bfe_u32 v33, v1, 1, 3
    v_mul_u32_u24 v33, 272, v33
    buffer_load_dwordx4 v21, s[28:31], s53 offen offset:1024 lds
    s_add_u32 s53, s53, 131072
    s_add_u32 m0, s75, 8192
    v_lshl_add_u32 v33, v27, 4, v33
    v_add_u32 v33, s61, v33
    v_and_b32 v34, 1, v1
    v_lshlrev_b32 v34, 1, v34
    s_and_b32 s60, s47, 3
    v_xor_b32 v34, s60, v34
    v_xor_b32 v35, 1, v34
    v_lshl_add_u32 v126, v34, 6, v33
    v_lshl_add_u32 v127, v35, 6, v33
    v_and_b32 v36, 15, v1
    v_lshlrev_b32 v36, 4, v36
    buffer_load_dwordx4 v20, s[28:31], s53 offen lds
    v_mul_u32_u24 v37, 272, v27
    v_add3_u32 v24, v37, v36, s61
    v_lshl_add_u32 v38, v27, 13, v36
    s_lshl2_add_u32 s60, s48, s44
    s_lshl_b32 s61, s60, 16
    s_lshl_b32 s62, s47, 8
    s_add_u32 s99, s61, s62
    s_add_u32 s100, s99, 32768
    s_add_u32 s92, s99, 0
    s_add_u32 s93, s100, 0
    s_mul_i32 s64, s60, 57344
    buffer_load_dwordx4 v21, s[28:31], s53 offen offset:1024 lds
    s_add_u32 s53, s53, 131072
    s_add_u32 m0, s75, 10240
    s_add_u32 s64, s64, 14680064
    s_and_b32 s61, s46, 3
    s_lshl2_add_u32 s61, s45, s61
    s_lshl2_add_u32 s61, s61, s44
    s_lshl_b32 s49, s61, 14
    s_add_u32 s50, s49, 8192
    s_add_u32 s66, s65, 393216
    s_waitcnt lgkmcnt(0)
    s_add_u32 s42, s42, 0x7f4a7c15
    s_addc_u32 s43, s43, 0x9e3779b9
    v_mov_b32 v22, s42
    v_mov_b32 v23, s43
    s_cmp_eq_u32 s44, 1
    s_cbranch_scc1 L_page52
    s_cmp_eq_u32 s44, 3
    s_cbranch_scc1 L_page32
L_ret2:
    buffer_load_dwordx4 v20, s[28:31], s53 offen lds
    buffer_load_dwordx4 v21, s[28:31], s53 offen offset:1024 lds
    s_add_u32 s53, s53, 131072
    s_add_u32 m0, s75, 12288
    s_nop 0
    buffer_load_dwordx4 v20, s[28:31], s53 offen lds
    buffer_load_dwordx4 v21, s[28:31], s53 offen offset:1024 lds
    s_add_u32 m0, s71, 132096
    s_nop 0
    buffer_load_dwordx4 v96, s[8:11], s70 offen lds
    buffer_load_dwordx4 v97, s[8:11], s70 offen offset:1024 lds
    s_add_u32 m0, s72, 131584
    s_mov_b64 exec, 0xff
    buffer_load_dwordx4 v98, s[8:11], 0 offen lds
    s_mov_b64 exec, -1
    s_add_u32 m0, s71, 140288
    s_nop 0
    buffer_load_dwordx4 v96, s[12:15], s70 offen lds
    buffer_load_dwordx4 v97, s[12:15], s70 offen offset:1024 lds
    buffer_load_dwordx2 v[124:125], v99, s[16:19], s101 offen
    s_waitcnt vmcnt(19)
    ds_read_b64_tr_b16 v[40:41], v12 offset:0
    ds_read_b64_tr_b16 v[42:43], v12 offset:1024
    ds_read_b64_tr_b16 v[44:45], v13 offset:0
    ds_read_b64_tr_b16 v[46:47], v13 offset:1024
    s_waitcnt vmcnt(16)
    ds_read_b64_tr_b16 v[48:49], v12 offset:2048
    ds_read_b64_tr_b16 v[50:51], v12 offset:3072
    ds_read_b64_tr_b16 v[52:53], v13 offset:2048
    ds_read_b64_tr_b16 v[54:55], v13 offset:3072
    s_waitcnt lgkmcnt(6)
    buffer_store_dwordx4 v[40:43], v2, s[36:39], s55 offen offset:0 sc1
    s_waitcnt lgkmcnt(4)
    buffer_store_dwordx4 v[44:47], v2, s[36:39], s55 offen offset:1024 sc1
    s_waitcnt vmcnt(16)
    ds_read_b64_tr_b16 v[56:57], v12 offset:4096
    ds_read_b64_tr_b16 v[58:59], v12 offset:5120
    ds_read_b64_tr_b16 v[60:61], v13 offset:4096
    ds_read_b64_tr_b16 v[62:63], v13 offset:5120
    s_waitcnt lgkmcnt(6)
    buffer_store_dwordx4 v[48:51], v2, s[36:39], s55 offen offset:2048 sc1
    s_waitcnt lgkmcnt(4)
    buffer_store_dwordx4 v[52:55], v2, s[36:39], s55 offen offset:3072 sc1
    s_add_u32 s55, s55, 4096
    s_waitcnt vmcnt(16)
    ds_read_b64_tr_b16 v[64:65], v12 offset:6144
    ds_read_b64_tr_b16 v[66:67], v12 offset:7168
    ds_read_b64_tr_b16 v[68:69], v13 offset:6144
    ds_read_b64_tr_b16 v[70:71], v13 offset:7168
    s_waitcnt lgkmcnt(6)
    buffer_store_dwordx4 v[56:59], v2, s[36:39], s55 offen offset:0 sc1
    s_waitcnt lgkmcnt(4)
    buffer_store_dwordx4 v[60:63], v2, s[36:39], s55 offen offset:1024 sc1
    s_waitcnt vmcnt(16)
    ds_read_b64_tr_b16 v[72:73], v12 offset:8192
    ds_read_b64_tr_b16 v[74:75], v12 offset:9216
    ds_read_b64_tr_b16 v[76:77], v13 offset:8192
    ds_read_b64_tr_b16 v[78:79], v13 offset:9216
    s_waitcnt lgkmcnt(6)
    buffer_store_dwordx4 v[64:67], v2, s[36:39], s55 offen offset:2048 sc1
    s_waitcnt lgkmcnt(4)
    buffer_store_dwordx4 v[68:71], v2, s[36:39], s55 offen offset:3072 sc1
    s_add_u32 s55, s55, 4096
    s_waitcnt vmcnt(16)
    ds_read_b64_tr_b16 v[80:81], v12 offset:10240
    ds_read_b64_tr_b16 v[82:83], v12 offset:11264
    ds_read_b64_tr_b16 v[84:85], v13 offset:10240
    ds_read_b64_tr_b16 v[86:87], v13 offset:11264
    s_waitcnt lgkmcnt(6)
    buffer_store_dwordx4 v[72:75], v2, s[36:39], s55 offen offset:0 sc1
    s_waitcnt lgkmcnt(4)
    buffer_store_dwordx4 v[76:79], v2, s[36:39], s55 offen offset:1024 sc1
    s_waitcnt vmcnt(16)
    ds_read_b64_tr_b16 v[88:89], v12 offset:12288
    ds_read_b64_tr_b16 v[90:91], v12 offset:13312
    ds_read_b64_tr_b16 v[92:93], v13 offset:12288
    ds_read_b64_tr_b16 v[94:95], v13 offset:13312
    s_waitcnt lgkmcnt(6)
    buffer_store_dwordx4 v[80:83], v2, s[36:39], s55 offen offset:2048 sc1
    s_waitcnt lgkmcnt(4)
    buffer_store_dwordx4 v[84:87], v2, s[36:39], s55 offen offset:3072 sc1
    s_add_u32 s55, s55, 4096
    s_waitcnt lgkmcnt(2)
    buffer_store_dwordx4 v[88:91], v2, s[36:39], s55 offen offset:0 sc1
    s_waitcnt lgkmcnt(0)
    buffer_store_dwordx4 v[92:95], v2, s[36:39], s55 offen offset:1024 sc1
    buffer_load_dwordx4 v[128:131], v3, s[4:7], s49 offen offset:0
    buffer_load_dwordx4 v[132:135], v3, s[4:7], s50 offen offset:0
    s_waitcnt vmcnt(2)
    s_barrier
    s_mov_b64 exec, 1
    buffer_store_dwordx2 v[22:23], off, s[36:39], s66 offset:0 sc1
    s_mov_b64 exec, -1
    s_barrier
    ds_read_b64_tr_b16 v[192:193], v255 offset:128
    ds_read_b64_tr_b16 v[194:195], v255 offset:256
    ds_read_b64_tr_b16 v[196:197], v255 offset:384
    ds_read_b64_tr_b16 v[198:199], v254 offset:0
    ds_read_b64_tr_b16 v[200:201], v254 offset:128
    ds_read_b64_tr_b16 v[202:203], v254 offset:256
    ds_read_b64_tr_b16 v[204:205], v254 offset:384
    ds_read_b64_tr_b16 v[206:207], v254 offset:8192
    ds_read_b64_tr_b16 v[208:209], v254 offset:8320
    ds_read_b64_tr_b16 v[210:211], v254 offset:8448
    ds_read_b64_tr_b16 v[212:213], v254 offset:8576
    v_lshlrev_b32 v112, 16, v124
    v_and_b32 v113, 0xffff0000, v124
    v_lshlrev_b32 v114, 16, v125
    v_and_b32 v115, 0xffff0000, v125
    s_waitcnt lgkmcnt(10)
    v_lshlrev_b32 v214, 16, v192
    v_and_b32 v215, 0xffff0000, v192
    v_lshlrev_b32 v216, 16, v193
    buffer_load_dwordx4 v[136:139], v3, s[4:7], s49 offen offset:128
    v_and_b32 v217, 0xffff0000, v193
    s_waitcnt lgkmcnt(9)
    v_lshlrev_b32 v218, 16, v194
    v_and_b32 v219, 0xffff0000, v194
    v_lshlrev_b32 v220, 16, v195
    v_and_b32 v221, 0xffff0000, v195
    s_waitcnt lgkmcnt(8)
    v_lshlrev_b32 v222, 16, v196
    v_and_b32 v223, 0xffff0000, v196
    buffer_load_dwordx4 v[140:143], v3, s[4:7], s50 offen offset:128
    v_lshlrev_b32 v224, 16, v197
    v_and_b32 v225, 0xffff0000, v197
    s_waitcnt lgkmcnt(7)
    v_lshlrev_b32 v226, 16, v198
    v_and_b32 v227, 0xffff0000, v198
    v_lshlrev_b32 v228, 16, v199
    v_and_b32 v229, 0xffff0000, v199
    buffer_load_dwordx4 v[144:147], v3, s[4:7], s49 offen offset:256
    s_waitcnt lgkmcnt(3)
    v_lshlrev_b32 v242, 16, v206
    v_and_b32 v243, 0xffff0000, v206
    v_lshlrev_b32 v244, 16, v207
    v_and_b32 v245, 0xffff0000, v207
    v_pk_mul_f32 v[250:251], v[214:215], v[114:115] op_sel:[0,1] op_sel_hi:[1,1]
    v_pk_mul_f32 v[252:253], v[216:217], v[114:115] op_sel:[0,1] op_sel_hi:[1,1]
    v_pk_fma_f32 v[250:251], v[218:219], v[114:115], v[250:251] op_sel:[0,0,0] op_sel_hi:[1,0,1]
    buffer_load_dwordx4 v[148:151], v3, s[4:7], s50 offen offset:256
    v_pk_fma_f32 v[252:253], v[220:221], v[114:115], v[252:253] op_sel:[0,0,0] op_sel_hi:[1,0,1]
    v_pk_fma_f32 v[250:251], v[222:223], v[112:113], v[250:251] op_sel:[0,1,0] op_sel_hi:[1,1,1]
    v_pk_fma_f32 v[252:253], v[224:225], v[112:113], v[252:253] op_sel:[0,1,0] op_sel_hi:[1,1,1]
    v_pk_fma_f32 v[250:251], v[226:227], v[112:113], v[250:251] op_sel:[0,0,0] op_sel_hi:[1,0,1]
    v_pk_fma_f32 v[252:253], v[228:229], v[112:113], v[252:253] op_sel:[0,0,0] op_sel_hi:[1,0,1]
    v_pk_mul_f32 v[250:251], v[250:251], v[242:243]
    buffer_load_dwordx4 v[152:155], v3, s[4:7], s49 offen offset:384
    v_pk_mul_f32 v[252:253], v[252:253], v[244:245]
    v_cvt_pk_bf16_f32 v116, v250, v251
    v_cvt_pk_bf16_f32 v117, v252, v253
    v_lshlrev_b32 v230, 16, v200
    v_and_b32 v231, 0xffff0000, v200
    v_lshlrev_b32 v232, 16, v201
    v_and_b32 v233, 0xffff0000, v201
    buffer_load_dwordx4 v[156:159], v3, s[4:7], s50 offen offset:384
    s_waitcnt lgkmcnt(2)
    v_lshlrev_b32 v246, 16, v208
    v_and_b32 v247, 0xffff0000, v208
    v_lshlrev_b32 v248, 16, v209
    v_and_b32 v249, 0xffff0000, v209
    v_pk_mul_f32 v[250:251], v[218:219], v[114:115] op_sel:[0,1] op_sel_hi:[1,1]
    v_pk_mul_f32 v[252:253], v[220:221], v[114:115] op_sel:[0,1] op_sel_hi:[1,1]
    buffer_load_dwordx4 v[160:163], v3, s[4:7], s49 offen offset:512
    v_pk_fma_f32 v[250:251], v[222:223], v[114:115], v[250:251] op_sel:[0,0,0] op_sel_hi:[1,0,1]
    v_pk_fma_f32 v[252:253], v[224:225], v[114:115], v[252:253] op_sel:[0,0,0] op_sel_hi:[1,0,1]
    v_pk_fma_f32 v[250:251], v[226:227], v[112:113], v[250:251] op_sel:[0,1,0] op_sel_hi:[1,1,1]
    v_pk_fma_f32 v[252:253], v[228:229], v[112:113], v[252:253] op_sel:[0,1,0] op_sel_hi:[1,1,1]
    v_pk_fma_f32 v[250:251], v[230:231], v[112:113], v[250:251] op_sel:[0,0,0] op_sel_hi:[1,0,1]
    v_pk_fma_f32 v[252:253], v[232:233], v[112:113], v[252:253] op_sel:[0,0,0] op_sel_hi:[1,0,1]
    v_pk_mul_f32 v[250:251], v[250:251], v[246:247]
    buffer_load_dwordx4 v[164:167], v3, s[4:7], s50 offen offset:512
    v_pk_mul_f32 v[252:253], v[252:253], v[248:249]
    v_cvt_pk_bf16_f32 v118, v250, v251
    v_cvt_pk_bf16_f32 v119, v252, v253
    ds_write_b128 v126, v[116:119]
    v_lshlrev_b32 v234, 16, v202
    v_and_b32 v235, 0xffff0000, v202
    buffer_load_dwordx4 v[168:171], v3, s[4:7], s49 offen offset:640
    v_lshlrev_b32 v236, 16, v203
    v_and_b32 v237, 0xffff0000, v203
    s_waitcnt lgkmcnt(2)
    v_lshlrev_b32 v242, 16, v210
    v_and_b32 v243, 0xffff0000, v210
    v_lshlrev_b32 v244, 16, v211
    v_and_b32 v245, 0xffff0000, v211
    v_pk_mul_f32 v[250:251], v[222:223], v[114:115] op_sel:[0,1] op_sel_hi:[1,1]
    buffer_load_dwordx4 v[172:175], v3, s[4:7], s50 offen offset:640
    v_pk_mul_f32 v[252:253], v[224:225], v[114:115] op_sel:[0,1] op_sel_hi:[1,1]
    v_pk_fma_f32 v[250:251], v[226:227], v[114:115], v[250:251] op_sel:[0,0,0] op_sel_hi:[1,0,1]
    v_pk_fma_f32 v[252:253], v[228:229], v[114:115], v[252:253] op_sel:[0,0,0] op_sel_hi:[1,0,1]
    v_pk_fma_f32 v[250:251], v[230:231], v[112:113], v[250:251] op_sel:[0,1,0] op_sel_hi:[1,1,1]
    v_pk_fma_f32 v[252:253], v[232:233], v[112:113], v[252:253] op_sel:[0,1,0] op_sel_hi:[1,1,1]
    v_pk_fma_f32 v[250:251], v[234:235], v[112:113], v[250:251] op_sel:[0,0,0] op_sel_hi:[1,0,1]
    buffer_load_dwordx4 v[176:179], v3, s[4:7], s49 offen offset:768
    v_pk_fma_f32 v[252:253], v[236:237], v[112:113], v[252:253] op_sel:[0,0,0] op_sel_hi:[1,0,1]
    v_pk_mul_f32 v[250:251], v[250:251], v[242:243]
    v_pk_mul_f32 v[252:253], v[252:253], v[244:245]
    v_cvt_pk_bf16_f32 v120, v250, v251
    v_cvt_pk_bf16_f32 v121, v252, v253
    v_lshlrev_b32 v238, 16, v204
    v_and_b32 v239, 0xffff0000, v204
    buffer_load_dwordx4 v[180:183], v3, s[4:7], s50 offen offset:768
    v_lshlrev_b32 v240, 16, v205
    v_and_b32 v241, 0xffff0000, v205
    s_waitcnt lgkmcnt(1)
    v_lshlrev_b32 v246, 16, v212
    v_and_b32 v247, 0xffff0000, v212
    v_lshlrev_b32 v248, 16, v213
    v_and_b32 v249, 0xffff0000, v213
    buffer_load_dwordx4 v[184:187], v3, s[4:7], s49 offen offset:896
    v_pk_mul_f32 v[250:251], v[226:227], v[114:115] op_sel:[0,1] op_sel_hi:[1,1]
    v_pk_mul_f32 v[252:253], v[228:229], v[114:115] op_sel:[0,1] op_sel_hi:[1,1]
    v_pk_fma_f32 v[250:251], v[230:231], v[114:115], v[250:251] op_sel:[0,0,0] op_sel_hi:[1,0,1]
    v_pk_fma_f32 v[252:253], v[232:233], v[114:115], v[252:253] op_sel:[0,0,0] op_sel_hi:[1,0,1]
    v_pk_fma_f32 v[250:251], v[234:235], v[112:113], v[250:251] op_sel:[0,1,0] op_sel_hi:[1,1,1]
    v_pk_fma_f32 v[252:253], v[236:237], v[112:113], v[252:253] op_sel:[0,1,0] op_sel_hi:[1,1,1]
    v_pk_fma_f32 v[250:251], v[238:239], v[112:113], v[250:251] op_sel:[0,0,0] op_sel_hi:[1,0,1]
    buffer_load_dwordx4 v[188:191], v3, s[4:7], s50 offen offset:896
    v_pk_fma_f32 v[252:253], v[240:241], v[112:113], v[252:253] op_sel:[0,0,0] op_sel_hi:[1,0,1]
    v_pk_mul_f32 v[250:251], v[250:251], v[246:247]
    v_pk_mul_f32 v[252:253], v[252:253], v[248:249]
    v_cvt_pk_bf16_f32 v122, v250, v251
    v_cvt_pk_bf16_f32 v123, v252, v253
    ds_write_b128 v127, v[120:123]
    ds_read_b128 v[116:119], v24
    ds_read_b128 v[120:123], v24 offset:1088
    s_waitcnt lgkmcnt(1)
    buffer_store_dwordx4 v[116:119], v38, s[36:39], s99 offen sc1
    s_waitcnt lgkmcnt(0)
    buffer_store_dwordx4 v[120:123], v38, s[36:39], s100 offen sc1
    s_mov_b32 s66, 16777216
    buffer_load_dwordx4 v[96:99], v2, s[20:23], s73 offen offset:0
    buffer_load_dwordx4 v[100:103], v2, s[20:23], s73 offen offset:1024
    buffer_load_dwordx4 v[104:107], v2, s[20:23], s73 offen offset:2048
    buffer_load_dwordx4 v[108:111], v2, s[20:23], s73 offen offset:3072
    s_lshl3_add_u32 s40, s44, s48
    s_lshl_b32 s40, s40, 7
    s_add_u32 s40, s40, 13004800
    v_mov_b32 v26, 0
    buffer_load_dwordx2 v[24:25], v26, s[36:39], s40 offen offset:0 sc1
    v_mov_b32 v27, 0x3f803f80
    v_mov_b32 v64, 0
    v_mov_b32 v65, 0
    v_mov_b32 v72, 0
    v_mov_b32 v73, 0
    s_waitcnt vmcnt(23)
    v_dot2c_f32_bf16 v64, v128, v27
    s_waitcnt vmcnt(22)
    v_dot2c_f32_bf16 v72, v132, v27
    v_dot2c_f32_bf16 v65, v129, v27
    v_dot2c_f32_bf16 v73, v133, v27
    v_dot2c_f32_bf16 v64, v130, v27
    v_dot2c_f32_bf16 v72, v134, v27
    v_dot2c_f32_bf16 v65, v131, v27
    v_dot2c_f32_bf16 v73, v135, v27
    s_waitcnt vmcnt(20)
    v_dot2c_f32_bf16 v64, v136, v27
    s_waitcnt vmcnt(19)
    v_dot2c_f32_bf16 v72, v140, v27
    v_dot2c_f32_bf16 v65, v137, v27
    v_dot2c_f32_bf16 v73, v141, v27
    v_dot2c_f32_bf16 v64, v138, v27
    v_dot2c_f32_bf16 v72, v142, v27
    v_dot2c_f32_bf16 v65, v139, v27
    v_dot2c_f32_bf16 v73, v143, v27
    s_waitcnt vmcnt(18)
    v_dot2c_f32_bf16 v64, v144, v27
    s_waitcnt vmcnt(17)
    v_dot2c_f32_bf16 v72, v148, v27
    v_dot2c_f32_bf16 v65, v145, v27
    v_dot2c_f32_bf16 v73, v149, v27
    v_dot2c_f32_bf16 v64, v146, v27
    v_dot2c_f32_bf16 v72, v150, v27
    v_dot2c_f32_bf16 v65, v147, v27
    v_dot2c_f32_bf16 v73, v151, v27
    s_waitcnt vmcnt(16)
    v_dot2c_f32_bf16 v64, v152, v27
    s_waitcnt vmcnt(15)
    v_dot2c_f32_bf16 v72, v156, v27
    v_dot2c_f32_bf16 v65, v153, v27
    v_dot2c_f32_bf16 v73, v157, v27
    v_dot2c_f32_bf16 v64, v154, v27
    v_dot2c_f32_bf16 v72, v158, v27
    v_dot2c_f32_bf16 v65, v155, v27
    v_dot2c_f32_bf16 v73, v159, v27
    s_waitcnt vmcnt(14)
    v_dot2c_f32_bf16 v64, v160, v27
    s_waitcnt vmcnt(13)
    v_dot2c_f32_bf16 v72, v164, v27
    v_dot2c_f32_bf16 v65, v161, v27
    v_dot2c_f32_bf16 v73, v165, v27
    v_dot2c_f32_bf16 v64, v162, v27
    v_dot2c_f32_bf16 v72, v166, v27
    v_dot2c_f32_bf16 v65, v163, v27
    v_dot2c_f32_bf16 v73, v167, v27
    s_waitcnt vmcnt(12)
    v_dot2c_f32_bf16 v64, v168, v27
    s_waitcnt vmcnt(11)
    v_dot2c_f32_bf16 v72, v172, v27
    v_dot2c_f32_bf16 v65, v169, v27
    v_dot2c_f32_bf16 v73, v173, v27
    v_dot2c_f32_bf16 v64, v170, v27
    v_dot2c_f32_bf16 v72, v174, v27
    v_dot2c_f32_bf16 v65, v171, v27
    v_dot2c_f32_bf16 v73, v175, v27
    s_waitcnt vmcnt(10)
    v_dot2c_f32_bf16 v64, v176, v27
    s_waitcnt vmcnt(9)
    v_dot2c_f32_bf16 v72, v180, v27
    v_dot2c_f32_bf16 v65, v177, v27
    v_dot2c_f32_bf16 v73, v181, v27
    v_dot2c_f32_bf16 v64, v178, v27
    v_dot2c_f32_bf16 v72, v182, v27
    v_dot2c_f32_bf16 v65, v179, v27
    v_dot2c_f32_bf16 v73, v183, v27
    s_waitcnt vmcnt(8)
    v_dot2c_f32_bf16 v64, v184, v27
    s_waitcnt vmcnt(7)
    v_dot2c_f32_bf16 v72, v188, v27
    v_dot2c_f32_bf16 v65, v185, v27
    v_dot2c_f32_bf16 v73, v189, v27
    v_dot2c_f32_bf16 v64, v186, v27
    v_dot2c_f32_bf16 v72, v190, v27
    v_dot2c_f32_bf16 v65, v187, v27
    v_dot2c_f32_bf16 v73, v191, v27
    s_nop 1
    v_add_f32 v64, v64, v65
    v_add_f32 v72, v72, v73
    s_nop 0
    v_add_f32_dpp v64, v64, v64 quad_perm:[1,0,3,2] row_mask:0xf bank_mask:0xf
    s_nop 1
    v_add_f32_dpp v64, v64, v64 quad_perm:[2,3,0,1] row_mask:0xf bank_mask:0xf
    s_nop 1
    v_add_f32_dpp v64, v64, v64 row_half_mirror row_mask:0xf bank_mask:0xf
    v_add_f32_dpp v72, v72, v72 quad_perm:[1,0,3,2] row_mask:0xf bank_mask:0xf
    s_nop 1
    v_add_f32_dpp v72, v72, v72 quad_perm:[2,3,0,1] row_mask:0xf bank_mask:0xf
    s_nop 1
    v_add_f32_dpp v72, v72, v72 row_half_mirror row_mask:0xf bank_mask:0xf
    v_mul_f32 v64, 0x3b000000, v64
    v_mov_b32 v66, 0
    v_mov_b32 v67, 0
    v_mul_f32 v72, 0x3b000000, v72
    v_mov_b32 v74, 0
    v_mov_b32 v75, 0
    s_waitcnt vmcnt(5)
    s_barrier
    s_mov_b64 exec, 1
    buffer_store_dwordx2 v[22:23], off, s[36:39], s65 offset:0 sc1
    s_mov_b64 exec, -1
    v_lshlrev_b32 v68, 16, v128
    v_and_b32 v69, 0xffff0000, v128
    v_pk_add_f32 v[68:69], v[68:69], v[64:65] op_sel:[0,0] op_sel_hi:[1,0] neg_lo:[0,1] neg_hi:[0,1]
    v_pk_fma_f32 v[66:67], v[68:69], v[68:69], v[66:67]
    v_lshlrev_b32 v76, 16, v132
    v_and_b32 v77, 0xffff0000, v132
    v_pk_add_f32 v[76:77], v[76:77], v[72:73] op_sel:[0,0] op_sel_hi:[1,0] neg_lo:[0,1] neg_hi:[0,1]
    v_pk_fma_f32 v[74:75], v[76:77], v[76:77], v[74:75]
    v_lshlrev_b32 v68, 16, v129
    v_and_b32 v69, 0xffff0000, v129
    v_pk_add_f32 v[68:69], v[68:69], v[64:65] op_sel:[0,0] op_sel_hi:[1,0] neg_lo:[0,1] neg_hi:[0,1]
    v_pk_fma_f32 v[66:67], v[68:69], v[68:69], v[66:67]
    v_lshlrev_b32 v76, 16, v133
    v_and_b32 v77, 0xffff0000, v133
    v_pk_add_f32 v[76:77], v[76:77], v[72:73] op_sel:[0,0] op_sel_hi:[1,0] neg_lo:[0,1] neg_hi:[0,1]
    v_pk_fma_f32 v[74:75], v[76:77], v[76:77], v[74:75]
    v_lshlrev_b32 v68, 16, v130
    v_and_b32 v69, 0xffff0000, v130
    v_pk_add_f32 v[68:69], v[68:69], v[64:65] op_sel:[0,0] op_sel_hi:[1,0] neg_lo:[0,1] neg_hi:[0,1]
    v_pk_fma_f32 v[66:67], v[68:69], v[68:69], v[66:67]
    v_lshlrev_b32 v76, 16, v134
    v_and_b32 v77, 0xffff0000, v134
    v_pk_add_f32 v[76:77], v[76:77], v[72:73] op_sel:[0,0] op_sel_hi:[1,0] neg_lo:[0,1] neg_hi:[0,1]
    v_pk_fma_f32 v[74:75], v[76:77], v[76:77], v[74:75]
    v_lshlrev_b32 v68, 16, v131
    v_and_b32 v69, 0xffff0000, v131
    v_pk_add_f32 v[68:69], v[68:69], v[64:65] op_sel:[0,0] op_sel_hi:[1,0] neg_lo:[0,1] neg_hi:[0,1]
    v_pk_fma_f32 v[66:67], v[68:69], v[68:69], v[66:67]
    v_lshlrev_b32 v76, 16, v135
    v_and_b32 v77, 0xffff0000, v135
    v_pk_add_f32 v[76:77], v[76:77], v[72:73] op_sel:[0,0] op_sel_hi:[1,0] neg_lo:[0,1] neg_hi:[0,1]
    v_pk_fma_f32 v[74:75], v[76:77], v[76:77], v[74:75]
    v_lshlrev_b32 v68, 16, v136
    v_and_b32 v69, 0xffff0000, v136
    v_pk_add_f32 v[68:69], v[68:69], v[64:65] op_sel:[0,0] op_sel_hi:[1,0] neg_lo:[0,1] neg_hi:[0,1]
    v_pk_fma_f32 v[66:67], v[68:69], v[68:69], v[66:67]
    v_lshlrev_b32 v76, 16, v140
    v_and_b32 v77, 0xffff0000, v140
    v_pk_add_f32 v[76:77], v[76:77], v[72:73] op_sel:[0,0] op_sel_hi:[1,0] neg_lo:[0,1] neg_hi:[0,1]
    v_pk_fma_f32 v[74:75], v[76:77], v[76:77], v[74:75]
    v_lshlrev_b32 v68, 16, v137
    v_and_b32 v69, 0xffff0000, v137
    v_pk_add_f32 v[68:69], v[68:69], v[64:65] op_sel:[0,0] op_sel_hi:[1,0] neg_lo:[0,1] neg_hi:[0,1]
    v_pk_fma_f32 v[66:67], v[68:69], v[68:69], v[66:67]
    v_lshlrev_b32 v76, 16, v141
    v_and_b32 v77, 0xffff0000, v141
    v_pk_add_f32 v[76:77], v[76:77], v[72:73] op_sel:[0,0] op_sel_hi:[1,0] neg_lo:[0,1] neg_hi:[0,1]
    v_pk_fma_f32 v[74:75], v[76:77], v[76:77], v[74:75]
    v_lshlrev_b32 v68, 16, v138
    v_and_b32 v69, 0xffff0000, v138
    v_pk_add_f32 v[68:69], v[68:69], v[64:65] op_sel:[0,0] op_sel_hi:[1,0] neg_lo:[0,1] neg_hi:[0,1]
    v_pk_fma_f32 v[66:67], v[68:69], v[68:69], v[66:67]
    v_lshlrev_b32 v76, 16, v142
    v_and_b32 v77, 0xffff0000, v142
    v_pk_add_f32 v[76:77], v[76:77], v[72:73] op_sel:[0,0] op_sel_hi:[1,0] neg_lo:[0,1] neg_hi:[0,1]
    v_pk_fma_f32 v[74:75], v[76:77], v[76:77], v[74:75]
    v_lshlrev_b32 v68, 16, v139
    v_and_b32 v69, 0xffff0000, v139
    v_pk_add_f32 v[68:69], v[68:69], v[64:65] op_sel:[0,0] op_sel_hi:[1,0] neg_lo:[0,1] neg_hi:[0,1]
    v_pk_fma_f32 v[66:67], v[68:69], v[68:69], v[66:67]
    v_lshlrev_b32 v76, 16, v143
    v_and_b32 v77, 0xffff0000, v143
    v_pk_add_f32 v[76:77], v[76:77], v[72:73] op_sel:[0,0] op_sel_hi:[1,0] neg_lo:[0,1] neg_hi:[0,1]
    v_pk_fma_f32 v[74:75], v[76:77], v[76:77], v[74:75]
    s_waitcnt vmcnt(1)
    v_cmp_ne_u64 vcc, s[42:43], v[24:25]
    s_cbranch_vccnz L_slow_w2s
L_back_w2s:
    v_lshlrev_b32 v68, 16, v144
    v_and_b32 v69, 0xffff0000, v144
    v_pk_add_f32 v[68:69], v[68:69], v[64:65] op_sel:[0,0] op_sel_hi:[1,0] neg_lo:[0,1] neg_hi:[0,1]
    v_pk_fma_f32 v[66:67], v[68:69], v[68:69], v[66:67]
    buffer_load_dwordx4 a[0:3], v2, s[36:39], s64 offen offset:0 sc1
    v_lshlrev_b32 v76, 16, v148
    v_and_b32 v77, 0xffff0000, v148
    v_pk_add_f32 v[76:77], v[76:77], v[72:73] op_sel:[0,0] op_sel_hi:[1,0] neg_lo:[0,1] neg_hi:[0,1]
    v_pk_fma_f32 v[74:75], v[76:77], v[76:77], v[74:75]
    v_lshlrev_b32 v68, 16, v145
    v_and_b32 v69, 0xffff0000, v145
    v_pk_add_f32 v[68:69], v[68:69], v[64:65] op_sel:[0,0] op_sel_hi:[1,0] neg_lo:[0,1] neg_hi:[0,1]
    v_pk_fma_f32 v[66:67], v[68:69], v[68:69], v[66:67]
    v_lshlrev_b32 v76, 16, v149
    v_and_b32 v77, 0xffff0000, v149
    v_pk_add_f32 v[76:77], v[76:77], v[72:73] op_sel:[0,0] op_sel_hi:[1,0] neg_lo:[0,1] neg_hi:[0,1]
    v_pk_fma_f32 v[74:75], v[76:77], v[76:77], v[74:75]
    buffer_load_dwordx4 a[4:7], v2, s[36:39], s64 offen offset:1024 sc1
    v_lshlrev_b32 v68, 16, v146
    v_and_b32 v69, 0xffff0000, v146
    v_pk_add_f32 v[68:69], v[68:69], v[64:65] op_sel:[0,0] op_sel_hi:[1,0] neg_lo:[0,1] neg_hi:[0,1]
    v_pk_fma_f32 v[66:67], v[68:69], v[68:69], v[66:67]
    v_lshlrev_b32 v76, 16, v150
    v_and_b32 v77, 0xffff0000, v150
    v_pk_add_f32 v[76:77], v[76:77], v[72:73] op_sel:[0,0] op_sel_hi:[1,0] neg_lo:[0,1] neg_hi:[0,1]
    v_pk_fma_f32 v[74:75], v[76:77], v[76:77], v[74:75]
    v_lshlrev_b32 v68, 16, v147
    v_and_b32 v69, 0xffff0000, v147
    v_pk_add_f32 v[68:69], v[68:69], v[64:65] op_sel:[0,0] op_sel_hi:[1,0] neg_lo:[0,1] neg_hi:[0,1]
    v_pk_fma_f32 v[66:67], v[68:69], v[68:69], v[66:67]
    buffer_load_dwordx4 a[8:11], v2, s[36:39], s64 offen offset:2048 sc1
    v_lshlrev_b32 v76, 16, v151
    v_and_b32 v77, 0xffff0000, v151
    v_pk_add_f32 v[76:77], v[76:77], v[72:73] op_sel:[0,0] op_sel_hi:[1,0] neg_lo:[0,1] neg_hi:[0,1]
    v_pk_fma_f32 v[74:75], v[76:77], v[76:77], v[74:75]
    v_lshlrev_b32 v68, 16, v152
    v_and_b32 v69, 0xffff0000, v152
    v_pk_add_f32 v[68:69], v[68:69], v[64:65] op_sel:[0,0] op_sel_hi:[1,0] neg_lo:[0,1] neg_hi:[0,1]
    v_pk_fma_f32 v[66:67], v[68:69], v[68:69], v[66:67]
    v_lshlrev_b32 v76, 16, v156
    v_and_b32 v77, 0xffff0000, v156
    v_pk_add_f32 v[76:77], v[76:77], v[72:73] op_sel:[0,0] op_sel_hi:[1,0] neg_lo:[0,1] neg_hi:[0,1]
    v_pk_fma_f32 v[74:75], v[76:77], v[76:77], v[74:75]
    v_lshlrev_b32 v68, 16, v153
    v_and_b32 v69, 0xffff0000, v153
    v_pk_add_f32 v[68:69], v[68:69], v[64:65] op_sel:[0,0] op_sel_hi:[1,0] neg_lo:[0,1] neg_hi:[0,1]
    v_pk_fma_f32 v[66:67], v[68:69], v[68:69], v[66:67]
    buffer_load_dwordx4 a[12:15], v2, s[36:39], s64 offen offset:3072 sc1
    s_add_u32 s64, s64, 4096
    v_lshlrev_b32 v76, 16, v157
    v_and_b32 v77, 0xffff0000, v157
    v_pk_add_f32 v[76:77], v[76:77], v[72:73] op_sel:[0,0] op_sel_hi:[1,0] neg_lo:[0,1] neg_hi:[0,1]
    v_pk_fma_f32 v[74:75], v[76:77], v[76:77], v[74:75]
    v_lshlrev_b32 v68, 16, v154
    v_and_b32 v69, 0xffff0000, v154
    v_pk_add_f32 v[68:69], v[68:69], v[64:65] op_sel:[0,0] op_sel_hi:[1,0] neg_lo:[0,1] neg_hi:[0,1]
    v_pk_fma_f32 v[66:67], v[68:69], v[68:69], v[66:67]
    v_lshlrev_b32 v76, 16, v158
    v_and_b32 v77, 0xffff0000, v158
    v_pk_add_f32 v[76:77], v[76:77], v[72:73] op_sel:[0,0] op_sel_hi:[1,0] neg_lo:[0,1] neg_hi:[0,1]
    v_pk_fma_f32 v[74:75], v[76:77], v[76:77], v[74:75]
    buffer_load_dwordx4 a[16:19], v2, s[36:39], s64 offen offset:0 sc1
    v_lshlrev_b32 v68, 16, v155
    v_and_b32 v69, 0xffff0000, v155
    v_pk_add_f32 v[68:69], v[68:69], v[64:65] op_sel:[0,0] op_sel_hi:[1,0] neg_lo:[0,1] neg_hi:[0,1]
    v_pk_fma_f32 v[66:67], v[68:69], v[68:69], v[66:67]
    v_lshlrev_b32 v76, 16, v159
    v_and_b32 v77, 0xffff0000, v159
    v_pk_add_f32 v[76:77], v[76:77], v[72:73] op_sel:[0,0] op_sel_hi:[1,0] neg_lo:[0,1] neg_hi:[0,1]
    v_pk_fma_f32 v[74:75], v[76:77], v[76:77], v[74:75]
    v_lshlrev_b32 v68, 16, v160
    v_and_b32 v69, 0xffff0000, v160
    v_pk_add_f32 v[68:69], v[68:69], v[64:65] op_sel:[0,0] op_sel_hi:[1,0] neg_lo:[0,1] neg_hi:[0,1]
    v_pk_fma_f32 v[66:67], v[68:69], v[68:69], v[66:67]
    v_lshlrev_b32 v76, 16, v164
    v_and_b32 v77, 0xffff0000, v164
    v_pk_add_f32 v[76:77], v[76:77], v[72:73] op_sel:[0,0] op_sel_hi:[1,0] neg_lo:[0,1] neg_hi:[0,1]
    v_pk_fma_f32 v[74:75], v[76:77], v[76:77], v[74:75]
    buffer_load_dwordx4 a[20:23], v2, s[36:39], s64 offen offset:1024 sc1
    v_lshlrev_b32 v68, 16, v161
    v_and_b32 v69, 0xffff0000, v161
    s_branch L_over5
L_page52:
    s_branch L_ret2
L_over5:
    v_pk_add_f32 v[68:69], v[68:69], v[64:65] op_sel:[0,0] op_sel_hi:[1,0] neg_lo:[0,1] neg_hi:[0,1]
    v_pk_fma_f32 v[66:67], v[68:69], v[68:69], v[66:67]
    v_lshlrev_b32 v76, 16, v165
    v_and_b32 v77, 0xffff0000, v165
    v_pk_add_f32 v[76:77], v[76:77], v[72:73] op_sel:[0,0] op_sel_hi:[1,0] neg_lo:[0,1] neg_hi:[0,1]
    v_pk_fma_f32 v[74:75], v[76:77], v[76:77], v[74:75]
    v_lshlrev_b32 v68, 16, v162
    v_and_b32 v69, 0xffff0000, v162
    v_pk_add_f32 v[68:69], v[68:69], v[64:65] op_sel:[0,0] op_sel_hi:[1,0] neg_lo:[0,1] neg_hi:[0,1]
    v_pk_fma_f32 v[66:67], v[68:69], v[68:69], v[66:67]
    buffer_load_dwordx4 a[24:27], v2, s[36:39], s64 offen offset:2048 sc1
    v_lshlrev_b32 v76, 16, v166
    v_and_b32 v77, 0xffff0000, v166
    v_pk_add_f32 v[76:77], v[76:77], v[72:73] op_sel:[0,0] op_sel_hi:[1,0] neg_lo:[0,1] neg_hi:[0,1]
    v_pk_fma_f32 v[74:75], v[76:77], v[76:77], v[74:75]
    v_lshlrev_b32 v68, 16, v163
    v_and_b32 v69, 0xffff0000, v163
    v_pk_add_f32 v[68:69], v[68:69], v[64:65] op_sel:[0,0] op_sel_hi:[1,0] neg_lo:[0,1] neg_hi:[0,1]
    v_pk_fma_f32 v[66:67], v[68:69], v[68:69], v[66:67]
    v_lshlrev_b32 v76, 16, v167
    v_and_b32 v77, 0xffff0000, v167
    v_pk_add_f32 v[76:77], v[76:77], v[72:73] op_sel:[0,0] op_sel_hi:[1,0] neg_lo:[0,1] neg_hi:[0,1]
    v_pk_fma_f32 v[74:75], v[76:77], v[76:77], v[74:75]
    v_lshlrev_b32 v68, 16, v168
    v_and_b32 v69, 0xffff0000, v168
    v_pk_add_f32 v[68:69], v[68:69], v[64:65] op_sel:[0,0] op_sel_hi:[1,0] neg_lo:[0,1] neg_hi:[0,1]
    v_pk_fma_f32 v[66:67], v[68:69], v[68:69], v[66:67]
    buffer_load_dwordx4 a[28:31], v2, s[36:39], s64 offen offset:3072 sc1
    s_add_u32 s64, s64, 4096
    v_lshlrev_b32 v76, 16, v172
    v_and_b32 v77, 0xffff0000, v172
    v_pk_add_f32 v[76:77], v[76:77], v[72:73] op_sel:[0,0] op_sel_hi:[1,0] neg_lo:[0,1] neg_hi:[0,1]
    v_pk_fma_f32 v[74:75], v[76:77], v[76:77], v[74:75]
    v_lshlrev_b32 v68, 16, v169
    v_and_b32 v69, 0xffff0000, v169
    v_pk_add_f32 v[68:69], v[68:69], v[64:65] op_sel:[0,0] op_sel_hi:[1,0] neg_lo:[0,1] neg_hi:[0,1]
    v_pk_fma_f32 v[66:67], v[68:69], v[68:69], v[66:67]
    v_lshlrev_b32 v76, 16, v173
    v_and_b32 v77, 0xffff0000, v173
    v_pk_add_f32 v[76:77], v[76:77], v[72:73] op_sel:[0,0] op_sel_hi:[1,0] neg_lo:[0,1] neg_hi:[0,1]
    v_pk_fma_f32 v[74:75], v[76:77], v[76:77], v[74:75]
    buffer_load_dwordx4 a[32:35], v2, s[36:39], s64 offen offset:0 sc1
    v_lshlrev_b32 v68, 16, v170
    v_and_b32 v69, 0xffff0000, v170
    v_pk_add_f32 v[68:69], v[68:69], v[64:65] op_sel:[0,0] op_sel_hi:[1,0] neg_lo:[0,1] neg_hi:[0,1]
    v_pk_fma_f32 v[66:67], v[68:69], v[68:69], v[66:67]
    v_lshlrev_b32 v76, 16, v174
    v_and_b32 v77, 0xffff0000, v174
    v_pk_add_f32 v[76:77], v[76:77], v[72:73] op_sel:[0,0] op_sel_hi:[1,0] neg_lo:[0,1] neg_hi:[0,1]
    v_pk_fma_f32 v[74:75], v[76:77], v[76:77], v[74:75]
    v_lshlrev_b32 v68, 16, v171
    v_and_b32 v69, 0xffff0000, v171
    v_pk_add_f32 v[68:69], v[68:69], v[64:65] op_sel:[0,0] op_sel_hi:[1,0] neg_lo:[0,1] neg_hi:[0,1]
    v_pk_fma_f32 v[66:67], v[68:69], v[68:69], v[66:67]
    buffer_load_dwordx4 a[36:39], v2, s[36:39], s64 offen offset:1024 sc1
    v_lshlrev_b32 v76, 16, v175
    v_and_b32 v77, 0xffff0000, v175
    v_pk_add_f32 v[76:77], v[76:77], v[72:73] op_sel:[0,0] op_sel_hi:[1,0] neg_lo:[0,1] neg_hi:[0,1]
    v_pk_fma_f32 v[74:75], v[76:77], v[76:77], v[74:75]
    v_lshlrev_b32 v68, 16, v176
    v_and_b32 v69, 0xffff0000, v176
    v_pk_add_f32 v[68:69], v[68:69], v[64:65] op_sel:[0,0] op_sel_hi:[1,0] neg_lo:[0,1] neg_hi:[0,1]
    v_pk_fma_f32 v[66:67], v[68:69], v[68:69], v[66:67]
    v_lshlrev_b32 v76, 16, v180
    v_and_b32 v77, 0xffff0000, v180
    v_pk_add_f32 v[76:77], v[76:77], v[72:73] op_sel:[0,0] op_sel_hi:[1,0] neg_lo:[0,1] neg_hi:[0,1]
    v_pk_fma_f32 v[74:75], v[76:77], v[76:77], v[74:75]
    v_lshlrev_b32 v68, 16, v177
    v_and_b32 v69, 0xffff0000, v177
    v_pk_add_f32 v[68:69], v[68:69], v[64:65] op_sel:[0,0] op_sel_hi:[1,0] neg_lo:[0,1] neg_hi:[0,1]
    v_pk_fma_f32 v[66:67], v[68:69], v[68:69], v[66:67]
    buffer_load_dwordx4 a[40:43], v2, s[36:39], s64 offen offset:2048 sc1
    v_lshlrev_b32 v76, 16, v181
    v_and_b32 v77, 0xffff0000, v181
    v_pk_add_f32 v[76:77], v[76:77], v[72:73] op_sel:[0,0] op_sel_hi:[1,0] neg_lo:[0,1] neg_hi:[0,1]
    v_pk_fma_f32 v[74:75], v[76:77], v[76:77], v[74:75]
    v_lshlrev_b32 v68, 16, v178
    v_and_b32 v69, 0xffff0000, v178
    v_pk_add_f32 v[68:69], v[68:69], v[64:65] op_sel:[0,0] op_sel_hi:[1,0] neg_lo:[0,1] neg_hi:[0,1]
    v_pk_fma_f32 v[66:67], v[68:69], v[68:69], v[66:67]
    v_lshlrev_b32 v76, 16, v182
    v_and_b32 v77, 0xffff0000, v182
    v_pk_add_f32 v[76:77], v[76:77], v[72:73] op_sel:[0,0] op_sel_hi:[1,0] neg_lo:[0,1] neg_hi:[0,1]
    v_pk_fma_f32 v[74:75], v[76:77], v[76:77], v[74:75]
    buffer_load_dwordx4 a[44:47], v2, s[36:39], s64 offen offset:3072 sc1
    s_add_u32 s64, s64, 4096
    v_lshlrev_b32 v68, 16, v179
    v_and_b32 v69, 0xffff0000, v179
    v_pk_add_f32 v[68:69], v[68:69], v[64:65] op_sel:[0,0] op_sel_hi:[1,0] neg_lo:[0,1] neg_hi:[0,1]
    v_pk_fma_f32 v[66:67], v[68:69], v[68:69], v[66:67]
    v_lshlrev_b32 v76, 16, v183
    v_and_b32 v77, 0xffff0000, v183
    v_pk_add_f32 v[76:77], v[76:77], v[72:73] op_sel:[0,0] op_sel_hi:[1,0] neg_lo:[0,1] neg_hi:[0,1]
    v_pk_fma_f32 v[74:75], v[76:77], v[76:77], v[74:75]
    v_lshlrev_b32 v68, 16, v184
    v_and_b32 v69, 0xffff0000, v184
    v_pk_add_f32 v[68:69], v[68:69], v[64:65] op_sel:[0,0] op_sel_hi:[1,0] neg_lo:[0,1] neg_hi:[0,1]
    v_pk_fma_f32 v[66:67], v[68:69], v[68:69], v[66:67]
    v_lshlrev_b32 v76, 16, v188
    v_and_b32 v77, 0xffff0000, v188
    v_pk_add_f32 v[76:77], v[76:77], v[72:73] op_sel:[0,0] op_sel_hi:[1,0] neg_lo:[0,1] neg_hi:[0,1]
    v_pk_fma_f32 v[74:75], v[76:77], v[76:77], v[74:75]
    buffer_load_dwordx4 a[48:51], v2, s[36:39], s64 offen offset:0 sc1
    v_lshlrev_b32 v68, 16, v185
    v_and_b32 v69, 0xffff0000, v185
    v_pk_add_f32 v[68:69], v[68:69], v[64:65] op_sel:[0,0] op_sel_hi:[1,0] neg_lo:[0,1] neg_hi:[0,1]
    v_pk_fma_f32 v[66:67], v[68:69], v[68:69], v[66:67]
    v_lshlrev_b32 v76, 16, v189
    v_and_b32 v77, 0xffff0000, v189
    v_pk_add_f32 v[76:77], v[76:77], v[72:73] op_sel:[0,0] op_sel_hi:[1,0] neg_lo:[0,1] neg_hi:[0,1]
    v_pk_fma_f32 v[74:75], v[76:77], v[76:77], v[74:75]
    v_lshlrev_b32 v68, 16, v186
    v_and_b32 v69, 0xffff0000, v186
    v_pk_add_f32 v[68:69], v[68:69], v[64:65] op_sel:[0,0] op_sel_hi:[1,0] neg_lo:[0,1] neg_hi:[0,1]
    v_pk_fma_f32 v[66:67], v[68:69], v[68:69], v[66:67]
    buffer_load_dwordx4 a[52:55], v2, s[36:39], s64 offen offset:1024 sc1
    v_lshlrev_b32 v76, 16, v190
    v_and_b32 v77, 0xffff0000, v190
    v_pk_add_f32 v[76:77], v[76:77], v[72:73] op_sel:[0,0] op_sel_hi:[1,0] neg_lo:[0,1] neg_hi:[0,1]
    v_pk_fma_f32 v[74:75], v[76:77], v[76:77], v[74:75]
    v_lshlrev_b32 v68, 16, v187
    v_and_b32 v69, 0xffff0000, v187
    v_pk_add_f32 v[68:69], v[68:69], v[64:65] op_sel:[0,0] op_sel_hi:[1,0] neg_lo:[0,1] neg_hi:[0,1]
    v_pk_fma_f32 v[66:67], v[68:69], v[68:69], v[66:67]
    v_lshlrev_b32 v76, 16, v191
    v_and_b32 v77, 0xffff0000, v191
    v_pk_add_f32 v[76:77], v[76:77], v[72:73] op_sel:[0,0] op_sel_hi:[1,0] neg_lo:[0,1] neg_hi:[0,1]
    v_pk_fma_f32 v[74:75], v[76:77], v[76:77], v[74:75]
    v_add_f32 v66, v66, v67
    v_add_f32 v74, v74, v75
    s_nop 0
    v_add_f32_dpp v66, v66, v66 quad_perm:[1,0,3,2] row_mask:0xf bank_mask:0xf
    s_nop 1
    v_add_f32_dpp v66, v66, v66 quad_perm:[2,3,0,1] row_mask:0xf bank_mask:0xf
    s_nop 1
    v_add_f32_dpp v66, v66, v66 row_half_mirror row_mask:0xf bank_mask:0xf
    v_add_f32_dpp v74, v74, v74 quad_perm:[1,0,3,2] row_mask:0xf bank_mask:0xf
    s_nop 1
    v_add_f32_dpp v74, v74, v74 quad_perm:[2,3,0,1] row_mask:0xf bank_mask:0xf
    s_nop 1
    v_add_f32_dpp v74, v74, v74 row_half_mirror row_mask:0xf bank_mask:0xf
    v_lshrrev_b32 v28, 3, v1
    v_lshlrev_b32 v28, 4, v28
    s_lshr_b32 s60, s49, 7
    s_add_u32 s60, s60, 13107200
    v_mul_f32 v66, 0x3b000000, v66
    v_cvt_pk_bf16_f32 v66, v66, v66
    v_lshlrev_b32 v66, 16, v66
    v_add_f32 v66, 0x3727c5ac, v66
    v_cvt_pk_bf16_f32 v66, v66, v66
    v_lshlrev_b32 v66, 16, v66
    v_sqrt_f32 v66, v66
    s_nop 0
    v_cvt_pk_bf16_f32 v68, v66, v64
    v_mov_b32 v70, v22
    v_mul_f32 v74, 0x3b000000, v74
    v_cvt_pk_bf16_f32 v74, v74, v74
    v_lshlrev_b32 v74, 16, v74
    v_add_f32 v74, 0x3727c5ac, v74
    v_cvt_pk_bf16_f32 v74, v74, v74
    v_lshlrev_b32 v74, 16, v74
    v_sqrt_f32 v74, v74
    s_nop 0
    v_cvt_pk_bf16_f32 v69, v74, v72
    v_mov_b32 v71, v23
    s_mov_b32 exec_lo, 0x01010101
    s_mov_b32 exec_hi, 0x01010101
    buffer_store_dwordx4 v[68:71], v28, s[36:39], s60 offen sc1
    s_mov_b64 exec, -1
    buffer_load_dwordx4 a[56:59], v2, s[36:39], s64 offen offset:2048 sc1
    v_and_b32 v26, 3, v1
    v_bfe_u32 v38, v1, 2, 1
    v_lshlrev_b32 v26, 13, v26
    v_lshl_add_u32 v26, v38, 7, v26
    s_lshr_b32 s40, s46, 2
    s_lshl2_add_u32 s40, s40, s44
    s_lshl_b32 s40, s40, 8
    s_add_u32 s40, s40, 12582912
    s_lshr_b32 s60, s44, 1
    s_lshl_b32 s60, s60, 4
    s_lshr_b32 s60, s56, s60
    s_lshl_b32 s60, s60, 16
    s_lshl_b32 s61, s58, 16
    v_mov_b32 v112, s60
    v_add_f32 v112, s61, v112
    v_cvt_pk_bf16_f32 v112, v112, v112
    buffer_load_dwordx4 a[60:63], v2, s[36:39], s64 offen offset:3072 sc1
    s_add_u32 s64, s64, 4096
    s_mul_i32 s62, s44, 8256
    v_mov_b32 v116, 0
    v_readfirstlane_b32 s60, v112
    v_mov_b32 v117, 0
    v_mov_b32 v118, 0
    v_mov_b32 v119, 0
    s_and_b32 s60, s60, 0xffff
    s_and_b32 s61, s58, 0xffff0000
    s_or_b32 s60, s60, s61
    s_bitcmp1_b32 s44, 0
    s_cselect_b32 s57, s60, s59
    s_cselect_b32 s60, 0, s60
    s_lshl_b32 s61, s60, 16
    s_lshl_b32 s63, s57, 16
    v_writelane_b32 v118, s60, 1
    s_lshr_b32 s60, s60, 16
    v_writelane_b32 v119, s57, 1
    s_cmp_lg_u32 s2, 224
    s_cbranch_scc1 L_nogen1
    v_lshlrev_b32 v32, 7, v0
    s_mov_b32 s74, 12582912
    buffer_load_dwordx2 v[30:31], v32, s[36:39], s74 offen sc1
L_nogen1:
    buffer_load_dwordx2 v[24:25], v26, s[36:39], s40 offen offset:0 sc1
    buffer_load_dwordx4 a[64:67], v2, s[36:39], s64 offen offset:0 sc1
    s_or_b32 s63, s63, s60
    v_writelane_b32 v118, s61, 3
    v_writelane_b32 v119, s63, 3
    v_and_b32 v112, 1, v1
    v_lshrrev_b32 v113, 1, v1
    v_mul_u32_u24 v113, 4128, v113
    buffer_load_dwordx4 a[68:71], v2, s[36:39], s64 offen offset:1024 sc1
    v_lshl_add_u32 v112, v112, 4, v113
    v_add_u32 v112, s62, v112
    v_add_u32 v114, s62, v2
    v_lshlrev_b32 v113, 2, v0
    s_mov_b64 exec, 15
    ds_write_b128 v112, v[116:119] offset:0
    s_mov_b64 exec, -1
    ds_write_b32 v113, v116 offset:33280
    buffer_load_dwordx4 a[72:75], v2, s[36:39], s64 offen offset:2048 sc1
    v_mov_b32 v115, s57
    v_readlane_b32 s57, v99, 63
    v_alignbyte_b32 v121, v97, v96, 2
    v_mov_b32_dpp v115, v99 wave_shr:1 row_mask:0xf bank_mask:0xf
    v_alignbyte_b32 v122, v98, v97, 2
    v_alignbyte_b32 v123, v99, v98, 2
    buffer_load_dwordx4 a[76:79], v2, s[36:39], s64 offen offset:3072 sc1
    s_add_u32 s64, s64, 4096
    v_alignbyte_b32 v120, v96, v115, 2
    ds_write_b128 v114, v[96:99] offset:32
    ds_write_b128 v114, v[120:123] offset:4160
    v_mov_b32 v115, s57
    v_readlane_b32 s57, v103, 63
    v_alignbyte_b32 v125, v101, v100, 2
    buffer_load_dwordx4 a[80:83], v2, s[36:39], s64 offen offset:0 sc1
    v_mov_b32_dpp v115, v103 wave_shr:1 row_mask:0xf bank_mask:0xf
    v_alignbyte_b32 v126, v102, v101, 2
    v_alignbyte_b32 v127, v103, v102, 2
    v_alignbyte_b32 v124, v100, v115, 2
    ds_write_b128 v114, v[100:103] offset:1056
    ds_write_b128 v114, v[124:127] offset:5184
    buffer_load_dwordx4 a[84:87], v2, s[36:39], s64 offen offset:1024 sc1
    v_mov_b32 v115, s57
    v_readlane_b32 s57, v107, 63
    v_alignbyte_b32 v121, v105, v104, 2
    v_mov_b32_dpp v115, v107 wave_shr:1 row_mask:0xf bank_mask:0xf
    v_alignbyte_b32 v122, v106, v105, 2
    v_alignbyte_b32 v123, v107, v106, 2
    buffer_load_dwordx4 a[88:91], v2, s[36:39], s64 offen offset:2048 sc1
    v_alignbyte_b32 v120, v104, v115, 2
    ds_write_b128 v114, v[104:107] offset:2080
    ds_write_b128 v114, v[120:123] offset:6208
    v_mov_b32 v115, s57
    v_readlane_b32 s57, v111, 63
    v_alignbyte_b32 v125, v109, v108, 2
    buffer_load_dwordx4 a[92:95], v2, s[36:39], s64 offen offset:3072 sc1
    s_add_u32 s64, s64, 4096
    v_mov_b32_dpp v115, v111 wave_shr:1 row_mask:0xf bank_mask:0xf
    v_alignbyte_b32 v126, v110, v109, 2
    v_alignbyte_b32 v127, v111, v110, 2
    v_alignbyte_b32 v124, v108, v115, 2
    ds_write_b128 v114, v[108:111] offset:3104
    ds_write_b128 v114, v[124:127] offset:7232
    s_waitcnt vmcnt(8)
    v_cmp_ne_u64 vcc, s[42:43], v[24:25]
    s_cbranch_vccnz L_slow_kv2
L_back_kv2:
    s_add_u32 m0, s71, 34304
    s_nop 0
    buffer_load_dwordx4 v2, s[36:39], s69 offen sc1 lds
    buffer_load_dwordx4 v2, s[36:39], s69 offen offset:1024 sc1 lds
    buffer_load_dwordx4 a[96:99], v2, s[36:39], s64 offen offset:0 sc1
    v_lshrrev_b32 v27, 4, v1
    v_bfe_u32 v28, v1, 2, 2
    v_and_b32 v29, 3, v1
    v_lshl_add_u32 v29, v27, 2, v29
    v_sub_u32 v29, v29, v28
    buffer_load_dwordx4 a[100:103], v2, s[36:39], s64 offen offset:1024 sc1
    s_mul_i32 s60, s44, 8256
    s_add_u32 s60, s60, 24
    v_lshlrev_b32 v29, 3, v29
    v_add_u32 v20, s60, v29
    buffer_load_dwordx4 a[104:107], v2, s[36:39], s64 offen offset:2048 sc1
    v_and_b32 v28, 15, v1
    v_sub_u32 v28, v28, v27
    v_add_u32 v28, 16, v28
    v_lshrrev_b32 v27, 2, v28
    v_and_b32 v28, 3, v28
    buffer_load_dwordx4 a[108:111], v2, s[36:39], s64 offen offset:3072 sc1
    s_add_u32 s64, s64, 4096
    v_lshlrev_b32 v28, 4, v28
    v_lshl_add_u32 v28, v27, 8, v28
    v_add_u32 v29, 0, v27
    v_xor_b32 v29, s44, v29
    buffer_load_dwordx4 a[112:115], v2, s[36:39], s64 offen offset:0 sc1
    v_and_b32 v29, 3, v29
    v_lshl_add_u32 v29, v29, 6, v28
    v_add_u32 v8, 33280, v29
    v_add_u32 v29, -1, v27
    v_xor_b32 v29, s44, v29
    buffer_load_dwordx4 a[116:119], v2, s[36:39], s64 offen offset:1024 sc1
    v_and_b32 v29, 3, v29
    v_lshl_add_u32 v29, v29, 6, v28
    v_add_u32 v9, 33024, v29
    v_add_u32 v29, -2, v27
    buffer_load_dwordx4 a[120:123], v2, s[36:39], s64 offen offset:2048 sc1
    v_xor_b32 v29, s44, v29
    v_and_b32 v29, 3, v29
    v_lshl_add_u32 v29, v29, 6, v28
    v_add_u32 v10, 32768, v29
    v_add_u32 v29, -3, v27
    buffer_load_dwordx4 a[124:127], v2, s[36:39], s64 offen offset:3072 sc1
    s_add_u32 s64, s64, 4096
    v_xor_b32 v29, s44, v29
    v_and_b32 v29, 3, v29
    v_lshl_add_u32 v29, v29, 6, v28
    v_add_u32 v11, 32512, v29
    s_mov_b32 s55, 16777216
    s_cmp_lg_u32 s2, 224
    s_cbranch_scc1 L_nogen2
    s_mov_b32 s67, 0
L_gen_spin:
    v_cmp_ne_u64 vcc, s[42:43], v[30:31]
    s_cbranch_vccz L_nogen2
    buffer_load_dwordx2 v[30:31], v32, s[36:39], s74 offen sc1
    s_add_u32 s67, s67, 1
    s_cmp_gt_u32 s67, 20000
    s_waitcnt vmcnt(0)
    s_cbranch_scc0 L_gen_spin
L_nogen2:
    s_waitcnt vmcnt(8) lgkmcnt(0)
    s_barrier
    ds_read_b128 v[160:163], v8 offset:0
    ds_read_b64_tr_b16 v[128:129], v20 offset:0
    ds_read_b64_tr_b16 v[130:131], v20 offset:4128
    ds_read_b128 v[164:167], v8 offset:1024
    ds_read_b64_tr_b16 v[132:133], v20 offset:512
    ds_read_b64_tr_b16 v[134:135], v20 offset:4640
    ds_read_b128 v[168:171], v8 offset:2048
    ds_read_b64_tr_b16 v[136:137], v20 offset:1024
    ds_read_b64_tr_b16 v[138:139], v20 offset:5152
    ds_read_b128 v[172:175], v8 offset:3072
    ds_read_b64_tr_b16 v[140:141], v20 offset:1536
    ds_read_b64_tr_b16 v[142:143], v20 offset:5664
    ds_read_b128 v[176:179], v8 offset:4096
    ds_read_b64_tr_b16 v[144:145], v20 offset:2048
    ds_read_b64_tr_b16 v[146:147], v20 offset:6176
    ds_read_b128 v[180:183], v8 offset:5120
    ds_read_b64_tr_b16 v[148:149], v20 offset:2560
    ds_read_b64_tr_b16 v[150:151], v20 offset:6688
    ds_read_b128 v[184:187], v8 offset:6144
    ds_read_b64_tr_b16 v[152:153], v20 offset:3072
    ds_read_b64_tr_b16 v[154:155], v20 offset:7200
    ds_read_b128 v[188:191], v8 offset:7168
    ds_read_b64_tr_b16 v[156:157], v20 offset:3584
    ds_read_b64_tr_b16 v[158:159], v20 offset:7712
    s_lshl2_add_u32 s74, s2, s44
    s_cmp_eq_u32 s74, 896
    s_cselect_b32 s74, 13172736, s66
    s_mov_b64 exec, 1
    buffer_store_dwordx2 v[22:23], off, s[36:39], s74 offset:0 sc1
    s_mov_b64 exec, -1
    s_waitcnt lgkmcnt(0)
    s_branch L_conv
L_codeend:

.section .rodata,"a"
.p2align 6
.amdhsa_kernel parallel_sum__ssm_conv_h3__dense_activation_relu__prompt_kernel
  .amdhsa_next_free_vgpr 512
  .amdhsa_next_free_sgpr 102
  .amdhsa_accum_offset 256
  .amdhsa_group_segment_fixed_size 0
  .amdhsa_kernarg_size 96
  .amdhsa_user_sgpr_count 2
  .amdhsa_user_sgpr_kernarg_segment_ptr 1
  .amdhsa_system_sgpr_workgroup_id_x 1
  .amdhsa_float_denorm_mode_32 3
.end_amdhsa_kernel
```
